```python
import torch

def _softmax(x, axis=-1):
    return torch.softmax(x, dim=axis)
def _gelu(x):
    return torch.nn.functional.gelu(x, approximate="tanh")
def _silu(x):
    return torch.nn.functional.silu(x)
def _sigmoid(x):
    return torch.sigmoid(x)
def _layernorm(x, axis=-1, eps=1e-5):
    m = x.mean(dim=axis, keepdim=True)
    v = x.var(dim=axis, keepdim=True, unbiased=False)
    return (x - m) / torch.sqrt(v + eps)
def _scatter_add(tgt, idx, src, axis=0):
    return tgt.clone().index_add_(axis, idx, src)
def _segment_sum(src, seg, n):
    out = torch.zeros((n,) + src.shape[1:], dtype=src.dtype)
    return out.index_add_(0, seg, src)
def _pad(x, pw):
    flat = tuple(v for pair in reversed(pw) for v in pair)
    return torch.nn.functional.pad(x, flat)

kernel_name = 'parallel_sum__ssm_conv_s4__dense_activation_squared_relu__prompt'

def setup_inputs():

    _w = (lambda a: (lambda t: t.to(torch.bfloat16) if t.is_floating_point() else t)(torch.as_tensor(a)))
    def _A_setup():
        B, L, D, N = 1, 2048, 512, 128
        A_re = -(lambda _x: torch.exp(torch.as_tensor(_x)))((lambda *s: torch.randn(*s, dtype=torch.bfloat16) * 3.2)(D, N))
        A_im = torch.pi * (lambda *s: torch.randn(*s, dtype=torch.bfloat16) * 0.2)(D, N)
        B_re = (lambda *s: torch.randn(*s, dtype=torch.bfloat16) * 0.4)(D, N)
        B_im = (lambda *s: torch.randn(*s, dtype=torch.bfloat16) * 0.4)(D, N)
        C_re = (lambda *s: torch.randn(*s, dtype=torch.bfloat16) * 0.4)(D, N)
        C_im = (lambda *s: torch.randn(*s, dtype=torch.bfloat16) * 0.4)(D, N)
        log_dt = (lambda *s: torch.randn(*s, dtype=torch.bfloat16) * 0.2)(D) * 0.5 - 4.0
        Dskip = (lambda *s: torch.randn(*s, dtype=torch.bfloat16) * 0.4)(D)
        return {
            "u": _w((lambda *s: torch.randn(*s, dtype=torch.bfloat16) * 0.05)(B, L, D)),
            "A_re": _w(A_re),
            "A_im": _w(A_im),
            "B_re": _w(B_re),
            "B_im": _w(B_im),
            "C_re": _w(C_re),
            "C_im": _w(C_im),
            "log_dt": _w(log_dt),
            "Dskip": _w(Dskip),
        }
    _A_in = _A_setup()

    def _B_setup():
        B, S, D, F = 1, 2048, 512, 1376
        return {
            "x": _w((lambda *s: torch.randn(*s, dtype=torch.bfloat16) * 0.05)(B, S, D)),
            "w1": _w((lambda *s: torch.randn(*s, dtype=torch.bfloat16) * 0.05)(D, F)),
            "b1": _w((lambda *s: torch.randn(*s, dtype=torch.bfloat16) * 0.2)(F)),
            "w2": _w((lambda *s: torch.randn(*s, dtype=torch.bfloat16) * 0.05)(F, D)),
            "b2": _w((lambda *s: torch.randn(*s, dtype=torch.bfloat16) * 0.8)(D)),
        }
    _B_in = _B_setup()

    return {
        "A_u": _A_in["u"],
        "A_A_re": _A_in["A_re"],
        "A_A_im": _A_in["A_im"],
        "A_B_re": _A_in["B_re"],
        "A_B_im": _A_in["B_im"],
        "A_C_re": _A_in["C_re"],
        "A_C_im": _A_in["C_im"],
        "A_log_dt": _A_in["log_dt"],
        "A_Dskip": _A_in["Dskip"],
        "B_x": _B_in["x"],
        "B_w1": _B_in["w1"],
        "B_b1": _B_in["b1"],
        "B_w2": _B_in["w2"],
        "B_b2": _B_in["b2"],
    }

def reference(A_u, A_A_re, A_A_im, A_B_re, A_B_im, A_C_re, A_C_im, A_log_dt, A_Dskip, B_x, B_w1, B_b1, B_w2, B_b2):
    def _A_ref(u, A_re, A_im, B_re, B_im, C_re, C_im, log_dt, Dskip):
        Bsz, L, D = u.shape
        dt = torch.exp(log_dt)[:, None]
        A = A_re + 1j * A_im
        Bc = B_re + 1j * B_im
        Cc = C_re + 1j * C_im
        logdA = dt * A
        dB = dt * Bc
        l = (lambda x, dt: x.to(dt))(torch.arange(L), A_re.dtype)
        P = torch.exp(logdA[:, :, None] * l[None, None, :])
        K = torch.einsum("dn,dnl,dn->dl", Cc, P, dB).real
        L2 = 2 * L
        Kp = _pad(K, ((0, 0), (0, L)))
        up = (lambda x, *d: x.permute(*d))(u, 0, 2, 1)
        up = _pad(up, ((0, 0), (0, 0), (0, L)))
        Kf = (lambda x, axes=(-2,-1): torch.fft.rfft2(x.float(), dim=axes))(Kp[:, None, :], axes=(-2, -1))
        Uf = (lambda x, axes=(-2,-1): torch.fft.rfft2(x.float(), dim=axes))(up[:, :, None, :], axes=(-2, -1))
        Yf = Uf * Kf[None, :, :, :]
        y = (lambda x, s, axes=(-2,-1): torch.fft.irfft2(x, s=s, dim=axes).to(torch.bfloat16))(Yf, (1, L2), axes=(-2, -1))[:, :, 0, :L]
        y = (lambda x, *d: x.permute(*d))(y, 0, 2, 1) + u * Dskip[None, None, :]
        return y

    def _B_ref(x, w1, b1, w2, b2):
        h = torch.einsum("bsd,df->bsf", x, w1) + b1
        zero = torch.zeros_like(h)
        r = torch.where(h > zero, h, zero)
        h = r * r
        out = torch.einsum("bsf,fd->bsd", h, w2) + b2
        return out

    x = A_u
    xn = _layernorm(x, axis=-1)
    return x + _A_ref(xn, A_A_re, A_A_im, A_B_re, A_B_im, A_C_re, A_C_im, A_log_dt, A_Dskip) + _B_ref(xn, B_w1, B_b1, B_w2, B_b2)
```

```asm
; @launch grid=(256,1,1) block=(512,1,1) lds=163840
.amdgcn_target "amdgcn-amd-amdhsa--gfx950"
.text
.globl parallel_sum__ssm_conv_s4__dense_activation_squared_relu__prompt_kernel
.p2align 8
.type parallel_sum__ssm_conv_s4__dense_activation_squared_relu__prompt_kernel,@function
parallel_sum__ssm_conv_s4__dense_activation_squared_relu__prompt_kernel:
    s_cmp_ge_u32 s2, 256
    s_cbranch_scc1 L_exit
    s_load_dwordx16 s[36:51], s[0:1], 0
    s_load_dwordx16 s[52:67], s[0:1], 64
    s_load_dwordx2 s[68:69], s[0:1], 128
    s_getpc_b64 s[4:5]
L_pc:
    v_and_b32 v1, 63, v0
    v_lshrrev_b32 v2, 6, v0
    s_lshr_b32 s82, s2, 3
    v_readfirstlane_b32 s70, v2
    s_lshl_b32 s82, s82, 3
    v_lshlrev_b32 v3, 0, v2
    v_add_u32 v3, v3, v1
    v_add_u32 v3, s82, v3
    v_lshlrev_b32 v3, 7, v3
    v_min_u32 v3, L_code_end-L_pc-4, v3
    s_mov_b64 exec, 1
    global_load_dword v124, v3, s[4:5]
    s_mov_b64 exec, -1
    s_lshr_b32 s79, s70, 2
    s_and_b32 s70, s70, 3
    s_and_b32 s80, s2, 7
    s_lshr_b32 s81, s2, 3
    s_and_b32 s81, s81, 3
    s_lshl_b32 s81, s81, 3
    s_add_u32 s71, s80, s81
    s_lshr_b32 s72, s2, 5
    s_lshr_b32 s73, s70, 1
    s_and_b32 s74, s70, 1
    s_lshl_b32 s80, s72, 6
    s_lshl_b32 s81, s71, 1
    s_add_u32 s80, s80, s81
    s_add_u32 s76, s80, s73
    s_mul_i32 s82, s72, 43
    s_add_u32 s83, s82, 2
    s_lshr_b32 s77, s83, 3
    s_add_u32 s83, s82, 45
    s_lshr_b32 s83, s83, 3
    s_sub_u32 s78, s83, s77
    s_waitcnt lgkmcnt(0)
    s_mov_b32 s8, s36
    s_mov_b32 s9, s37
    s_mov_b32 s10, 0x200000
    s_mov_b32 s11, 0x20000
    s_mov_b32 s12, s56
    s_mov_b32 s13, s57
    s_mov_b32 s14, 0x158000
    s_mov_b32 s15, 0x20000
    s_mov_b32 s16, s60
    s_mov_b32 s17, s61
    s_mov_b32 s18, 0x158000
    s_mov_b32 s19, 0x20000
    s_mov_b32 s20, s68
    s_mov_b32 s21, s69
    s_mov_b32 s22, 0x4000000
    s_mov_b32 s23, 0x20000
    s_mov_b32 s24, s64
    s_mov_b32 s25, s65
    s_mov_b32 s26, 0x200000
    s_mov_b32 s27, 0x20000
    s_mov_b32 s28, s66
    s_mov_b32 s29, s67
    s_mov_b32 s30, 0x100
    s_mov_b32 s31, 0x20000
    s_cmp_lg_u32 s79, 0
    s_cbranch_scc1 L_helper
    s_lshl_b32 s80, s76, 8
    s_lshl_b32 s81, s74, 7
    s_add_u32 s80, s80, s81
    v_lshlrev_b32 v10, 1, v1
    v_add_u32 v10, s80, v10
    global_load_ushort v108, v10, s[38:39]
    global_load_ushort v109, v10, s[40:41]
    global_load_ushort v110, v10, s[42:43]
    global_load_ushort v111, v10, s[44:45]
    global_load_ushort v112, v10, s[46:47]
    global_load_ushort v113, v10, s[48:49]
    s_and_b32 s80, s76, 0x1fe
    s_lshl_b32 s80, s80, 1
    s_load_dword s42, s[50:51], s80
    s_lshl_b32 s80, s71, 16
    s_lshl_b32 s81, s72, 13
    s_add_u32 s80, s80, s81
    s_lshl_b32 s81, s70, 11
    s_add_u32 s80, s80, s81
    v_lshlrev_b32 v2, 7, v1
    s_mov_b64 exec, 0xffff
    buffer_load_dword v115, v2, s[8:11], s80 offen
    s_mov_b64 exec, -1
    s_mul_i32 s90, s2, 5504
    s_mul_i32 s91, s70, 1408
    s_add_u32 s90, s90, s91
    v_lshlrev_b32 v114, 7, v1
    s_mov_b64 exec, 2047
    buffer_load_dword v123, v114, s[12:15], s90 offen
    s_mov_b64 exec, -1
    v_lshrrev_b32 v2, 5, v1
    v_lshrrev_b32 v3, 2, v1
    v_and_b32 v3, 3, v3
    v_lshl_add_u32 v3, v2, 3, v3
    v_lshlrev_b32 v3, 6, v3
    v_lshrrev_b32 v4, 4, v1
    v_and_b32 v4, 1, v4
    v_lshl_add_u32 v3, v4, 5, v3
    v_and_b32 v4, 3, v1
    v_lshl_add_u32 v122, v4, 3, v3
    s_mul_i32 s80, s74, 6144
    s_lshl_b32 s81, s73, 10
    s_add_u32 s82, s80, s81
    s_sub_u32 s83, s80, s81
    s_add_u32 s83, s83, 1024
    v_add_u32 v116, s82, v122
    v_add_u32 v119, s83, v122
    v_add_u32 v117, s82, v122
    v_add_u32 v120, s83, v122
    v_add_u32 v117, 65536, v117
    v_add_u32 v120, 65536, v120
    v_add_u32 v118, s82, v122
    v_add_u32 v121, s83, v122
    v_add_u32 v118, 131072, v118
    v_add_u32 v121, 131072, v121
    s_mul_i32 s44, s70, 8704
    s_add_u32 s44, s44, 114688
    s_xor_b32 s45, s70, 1
    s_mul_i32 s45, s45, 8704
    s_add_u32 s45, s45, 114688
    v_lshlrev_b32 v4, 2, v1
    v_add_u32 v82, s44, v4
    v_add_u32 v83, s44, v4
    v_add_u32 v83, 1088, v83
    v_add_u32 v84, s44, v4
    v_add_u32 v84, 2176, v84
    v_add_u32 v85, s44, v4
    v_add_u32 v85, 3264, v85
    v_add_u32 v86, s44, v4
    v_add_u32 v86, 4352, v86
    v_add_u32 v87, s44, v4
    v_add_u32 v87, 5440, v87
    v_add_u32 v88, s44, v4
    v_add_u32 v88, 6528, v88
    v_add_u32 v89, s44, v4
    v_add_u32 v89, 7616, v89
    v_and_b32 v90, 31, v1
    v_lshrrev_b32 v5, 5, v1
    s_lshl_b32 s87, s74, 4
    v_xor_b32 v91, s87, v90
    v_mul_u32_u24 v91, 272, v91
    v_mul_u32_u24 v90, 272, v90
    v_lshl_add_u32 v91, v5, 4, v91
    v_lshl_add_u32 v90, v5, 4, v90
    v_add_u32 v91, s44, v91
    v_add_u32 v90, s44, v90
    s_lshl_b32 s86, s73, 4
    s_waitcnt lgkmcnt(0)
    s_lshr_b32 s42, s42, s86
    s_lshl_b32 s42, s42, 16
    v_mov_b32 v2, s42
    v_mul_f32 v3, 0x3fb8aa3b, v2
    v_mov_b32 v4, 0x3fb8aa3b
    v_fma_f32 v5, v2, v4, -v3
    v_mov_b32 v4, 0x32a57060
    v_exp_f32 v3, v3
    v_fma_f32 v5, v2, v4, v5
    v_mul_f32 v5, 0x3f317218, v5
    v_fma_f32 v3, v3, v5, v3
    v_cvt_pk_bf16_f32 v3, v3, v3
    v_lshlrev_b32 v2, 16, v3
    s_waitcnt vmcnt(7)
    v_lshlrev_b32 v108, 16, v108
    s_waitcnt vmcnt(6)
    v_lshlrev_b32 v109, 16, v109
    s_waitcnt vmcnt(5)
    v_lshlrev_b32 v110, 16, v110
    s_waitcnt vmcnt(4)
    v_lshlrev_b32 v111, 16, v111
    s_waitcnt vmcnt(3)
    v_lshlrev_b32 v112, 16, v112
    s_waitcnt vmcnt(2)
    v_lshlrev_b32 v113, 16, v113
    v_mul_f32 v4, v2, v108
    v_mul_f32 v5, v2, v109
    v_mul_f32 v6, v2, v110
    v_mul_f32 v10, 0x3fb8aa3b, v4
    v_mul_f32 v11, 0x3e22f983, v5
    v_mul_f32 v7, v2, v111
    v_exp_f32 v10, v10
    v_sin_f32 v13, v11
    v_cos_f32 v12, v11
    v_pk_mul_f32 v[68:69], v[112:113], v[6:7] op_sel:[0,0] op_sel_hi:[0,1]
    v_pk_fma_f32 v[8:9], v[112:113], v[6:7], v[68:69] op_sel:[1,1,0] op_sel_hi:[1,0,1] neg_lo:[1,0,0]
    v_mul_f32 v14, v10, v12
    v_mul_f32 v15, v10, v13
    v_pk_mul_f32 v[68:69], v[14:15], v[14:15] op_sel:[0,0] op_sel_hi:[0,1]
    v_pk_fma_f32 v[16:17], v[14:15], v[14:15], v[68:69] op_sel:[1,1,0] op_sel_hi:[1,0,1] neg_lo:[1,0,0]
    v_pk_mul_f32 v[68:69], v[16:17], v[16:17] op_sel:[0,0] op_sel_hi:[0,1]
    v_pk_mul_f32 v[70:71], v[16:17], v[14:15] op_sel:[0,0] op_sel_hi:[0,1]
    v_pk_fma_f32 v[20:21], v[16:17], v[16:17], v[68:69] op_sel:[1,1,0] op_sel_hi:[1,0,1] neg_lo:[1,0,0]
    v_pk_fma_f32 v[18:19], v[16:17], v[14:15], v[70:71] op_sel:[1,1,0] op_sel_hi:[1,0,1] neg_lo:[1,0,0]
    v_mov_b32 v78, 0x3f80
    v_cvt_pk_bf16_f32 v79, v14, v15
    ds_write2_b32 v82, v78, v79 offset0:0 offset1:68
    v_pk_mul_f32 v[68:69], v[20:21], v[20:21] op_sel:[0,0] op_sel_hi:[0,1]
    v_pk_mul_f32 v[70:71], v[20:21], v[14:15] op_sel:[0,0] op_sel_hi:[0,1]
    v_pk_mul_f32 v[72:73], v[20:21], v[16:17] op_sel:[0,0] op_sel_hi:[0,1]
    v_pk_mul_f32 v[74:75], v[20:21], v[18:19] op_sel:[0,0] op_sel_hi:[0,1]
    v_pk_fma_f32 v[28:29], v[20:21], v[20:21], v[68:69] op_sel:[1,1,0] op_sel_hi:[1,0,1] neg_lo:[1,0,0]
    v_pk_fma_f32 v[22:23], v[20:21], v[14:15], v[70:71] op_sel:[1,1,0] op_sel_hi:[1,0,1] neg_lo:[1,0,0]
    v_pk_fma_f32 v[24:25], v[20:21], v[16:17], v[72:73] op_sel:[1,1,0] op_sel_hi:[1,0,1] neg_lo:[1,0,0]
    v_pk_fma_f32 v[26:27], v[20:21], v[18:19], v[74:75] op_sel:[1,1,0] op_sel_hi:[1,0,1] neg_lo:[1,0,0]
    v_cvt_pk_bf16_f32 v80, v16, v17
    v_cvt_pk_bf16_f32 v81, v18, v19
    ds_write2_b32 v82, v80, v81 offset0:136 offset1:204
    v_pk_mul_f32 v[68:69], v[28:29], v[28:29] op_sel:[0,0] op_sel_hi:[0,1]
    v_pk_mul_f32 v[70:71], v[8:9], v[28:29] op_sel:[0,0] op_sel_hi:[0,1]
    v_pk_fma_f32 v[30:31], v[28:29], v[28:29], v[68:69] op_sel:[1,1,0] op_sel_hi:[1,0,1] neg_lo:[1,0,0]
    v_pk_fma_f32 v[54:55], v[8:9], v[28:29], v[70:71] op_sel:[1,1,0] op_sel_hi:[1,0,1] neg_lo:[1,0,0]
    v_cvt_pk_bf16_f32 v78, v20, v21
    v_cvt_pk_bf16_f32 v79, v22, v23
    ds_write2_b32 v83, v78, v79 offset0:0 offset1:68
    v_pk_mul_f32 v[68:69], v[30:31], v[30:31] op_sel:[0,0] op_sel_hi:[0,1]
    v_pk_mul_f32 v[70:71], v[8:9], v[30:31] op_sel:[0,0] op_sel_hi:[0,1]
    v_pk_mul_f32 v[72:73], v[54:55], v[30:31] op_sel:[0,0] op_sel_hi:[0,1]
    v_pk_fma_f32 v[32:33], v[30:31], v[30:31], v[68:69] op_sel:[1,1,0] op_sel_hi:[1,0,1] neg_lo:[1,0,0]
    v_pk_fma_f32 v[56:57], v[8:9], v[30:31], v[70:71] op_sel:[1,1,0] op_sel_hi:[1,0,1] neg_lo:[1,0,0]
    v_pk_fma_f32 v[58:59], v[54:55], v[30:31], v[72:73] op_sel:[1,1,0] op_sel_hi:[1,0,1] neg_lo:[1,0,0]
    v_cvt_pk_bf16_f32 v80, v24, v25
    v_cvt_pk_bf16_f32 v81, v26, v27
    ds_write2_b32 v83, v80, v81 offset0:136 offset1:204
    v_mov_b32 v52, v8
    v_pk_mul_f32 v[68:69], v[32:33], v[32:33] op_sel:[0,0] op_sel_hi:[0,1]
    v_pk_fma_f32 v[34:35], v[32:33], v[32:33], v[68:69] op_sel:[1,1,0] op_sel_hi:[1,0,1] neg_lo:[1,0,0]
    v_mov_b32 v53, v9
    v_pk_mul_f32 v[68:69], v[34:35], v[34:35] op_sel:[0,0] op_sel_hi:[0,1]
    v_pk_fma_f32 v[36:37], v[34:35], v[34:35], v[68:69] op_sel:[1,1,0] op_sel_hi:[1,0,1] neg_lo:[1,0,0]
    v_pk_mul_f32 v[68:69], v[36:37], v[36:37] op_sel:[0,0] op_sel_hi:[0,1]
    v_pk_fma_f32 v[38:39], v[36:37], v[36:37], v[68:69] op_sel:[1,1,0] op_sel_hi:[1,0,1] neg_lo:[1,0,0]
    v_pk_mul_f32 v[68:69], v[38:39], v[38:39] op_sel:[0,0] op_sel_hi:[0,1]
    v_pk_mul_f32 v[70:71], v[38:39], v[16:17] op_sel:[0,0] op_sel_hi:[0,1]
    v_pk_mul_f32 v[72:73], v[38:39], v[20:21] op_sel:[0,0] op_sel_hi:[0,1]
    v_pk_mul_f32 v[74:75], v[38:39], v[24:25] op_sel:[0,0] op_sel_hi:[0,1]
    v_pk_mul_f32 v[76:77], v[38:39], v[28:29] op_sel:[0,0] op_sel_hi:[0,1]
    v_pk_fma_f32 v[40:41], v[38:39], v[38:39], v[68:69] op_sel:[1,1,0] op_sel_hi:[1,0,1] neg_lo:[1,0,0]
    v_pk_fma_f32 v[60:61], v[38:39], v[16:17], v[70:71] op_sel:[1,1,0] op_sel_hi:[1,0,1] neg_lo:[1,0,0]
    v_pk_fma_f32 v[62:63], v[38:39], v[20:21], v[72:73] op_sel:[1,1,0] op_sel_hi:[1,0,1] neg_lo:[1,0,0]
    v_pk_fma_f32 v[64:65], v[38:39], v[24:25], v[74:75] op_sel:[1,1,0] op_sel_hi:[1,0,1] neg_lo:[1,0,0]
    v_pk_fma_f32 v[66:67], v[38:39], v[28:29], v[76:77] op_sel:[1,1,0] op_sel_hi:[1,0,1] neg_lo:[1,0,0]
    v_cvt_pk_bf16_f32 v78, v38, v39
    v_cvt_pk_bf16_f32 v79, v60, v61
    ds_write2_b32 v84, v78, v79 offset0:0 offset1:68
    v_pk_mul_f32 v[68:69], v[40:41], v[40:41] op_sel:[0,0] op_sel_hi:[0,1]
    v_pk_mul_f32 v[70:71], v[40:41], v[38:39] op_sel:[0,0] op_sel_hi:[0,1]
    v_pk_fma_f32 v[42:43], v[40:41], v[40:41], v[68:69] op_sel:[1,1,0] op_sel_hi:[1,0,1] neg_lo:[1,0,0]
    v_pk_fma_f32 v[44:45], v[40:41], v[38:39], v[70:71] op_sel:[1,1,0] op_sel_hi:[1,0,1] neg_lo:[1,0,0]
    v_cvt_pk_bf16_f32 v80, v62, v63
    v_cvt_pk_bf16_f32 v81, v62, v63
    ds_write2_b32 v84, v80, v81 offset0:136 offset1:204
    v_cvt_pk_bf16_f32 v78, v62, v63
    v_cvt_pk_bf16_f32 v79, v64, v65
    ds_write2_b32 v85, v78, v79 offset0:0 offset1:68
    v_cvt_pk_bf16_f32 v80, v66, v67
    v_cvt_pk_bf16_f32 v81, v66, v67
    ds_write2_b32 v85, v80, v81 offset0:136 offset1:204
    v_pk_mul_f32 v[68:69], v[40:41], v[20:21] op_sel:[0,0] op_sel_hi:[0,1]
    v_pk_mul_f32 v[70:71], v[40:41], v[28:29] op_sel:[0,0] op_sel_hi:[0,1]
    v_pk_mul_f32 v[72:73], v[42:43], v[38:39] op_sel:[0,0] op_sel_hi:[0,1]
    v_pk_mul_f32 v[74:75], v[42:43], v[40:41] op_sel:[0,0] op_sel_hi:[0,1]
    v_pk_fma_f32 v[60:61], v[40:41], v[20:21], v[68:69] op_sel:[1,1,0] op_sel_hi:[1,0,1] neg_lo:[1,0,0]
    v_pk_fma_f32 v[62:63], v[40:41], v[28:29], v[70:71] op_sel:[1,1,0] op_sel_hi:[1,0,1] neg_lo:[1,0,0]
    v_pk_fma_f32 v[46:47], v[42:43], v[38:39], v[72:73] op_sel:[1,1,0] op_sel_hi:[1,0,1] neg_lo:[1,0,0]
    v_pk_fma_f32 v[48:49], v[42:43], v[40:41], v[74:75] op_sel:[1,1,0] op_sel_hi:[1,0,1] neg_lo:[1,0,0]
    v_cvt_pk_bf16_f32 v78, v40, v41
    v_cvt_pk_bf16_f32 v79, v60, v61
    ds_write2_b32 v86, v78, v79 offset0:0 offset1:68
    v_cvt_pk_bf16_f32 v80, v62, v63
    v_cvt_pk_bf16_f32 v81, v62, v63
    ds_write2_b32 v86, v80, v81 offset0:136 offset1:204
    v_pk_mul_f32 v[68:69], v[44:45], v[20:21] op_sel:[0,0] op_sel_hi:[0,1]
    v_pk_mul_f32 v[70:71], v[44:45], v[28:29] op_sel:[0,0] op_sel_hi:[0,1]
    v_pk_mul_f32 v[72:73], v[48:49], v[38:39] op_sel:[0,0] op_sel_hi:[0,1]
    v_pk_fma_f32 v[64:65], v[44:45], v[20:21], v[68:69] op_sel:[1,1,0] op_sel_hi:[1,0,1] neg_lo:[1,0,0]
    v_pk_fma_f32 v[66:67], v[44:45], v[28:29], v[70:71] op_sel:[1,1,0] op_sel_hi:[1,0,1] neg_lo:[1,0,0]
    v_pk_fma_f32 v[50:51], v[48:49], v[38:39], v[72:73] op_sel:[1,1,0] op_sel_hi:[1,0,1] neg_lo:[1,0,0]
    v_cvt_pk_bf16_f32 v78, v44, v45
    v_cvt_pk_bf16_f32 v79, v64, v65
    ds_write2_b32 v87, v78, v79 offset0:0 offset1:68
    v_cvt_pk_bf16_f32 v80, v66, v67
    v_cvt_pk_bf16_f32 v81, v66, v67
    ds_write2_b32 v87, v80, v81 offset0:136 offset1:204
    v_pk_mul_f32 v[68:69], v[42:43], v[28:29] op_sel:[0,0] op_sel_hi:[0,1]
    v_pk_mul_f32 v[70:71], v[46:47], v[28:29] op_sel:[0,0] op_sel_hi:[0,1]
    v_pk_mul_f32 v[72:73], v[48:49], v[28:29] op_sel:[0,0] op_sel_hi:[0,1]
    v_pk_mul_f32 v[74:75], v[50:51], v[28:29] op_sel:[0,0] op_sel_hi:[0,1]
    v_pk_fma_f32 v[60:61], v[42:43], v[28:29], v[68:69] op_sel:[1,1,0] op_sel_hi:[1,0,1] neg_lo:[1,0,0]
    v_pk_fma_f32 v[62:63], v[46:47], v[28:29], v[70:71] op_sel:[1,1,0] op_sel_hi:[1,0,1] neg_lo:[1,0,0]
    v_pk_fma_f32 v[64:65], v[48:49], v[28:29], v[72:73] op_sel:[1,1,0] op_sel_hi:[1,0,1] neg_lo:[1,0,0]
    v_pk_fma_f32 v[66:67], v[50:51], v[28:29], v[74:75] op_sel:[1,1,0] op_sel_hi:[1,0,1] neg_lo:[1,0,0]
    v_cvt_pk_bf16_f32 v78, v42, v43
    v_cvt_pk_bf16_f32 v79, v60, v61
    ds_write2_b32 v88, v78, v79 offset0:0 offset1:68
    v_cvt_pk_bf16_f32 v80, v46, v47
    v_cvt_pk_bf16_f32 v81, v62, v63
    ds_write2_b32 v88, v80, v81 offset0:136 offset1:204
    v_cvt_pk_bf16_f32 v78, v48, v49
    v_cvt_pk_bf16_f32 v79, v64, v65
    ds_write2_b32 v89, v78, v79 offset0:0 offset1:68
    v_cvt_pk_bf16_f32 v80, v50, v51
    v_cvt_pk_bf16_f32 v81, v66, v67
    ds_write2_b32 v89, v80, v81 offset0:136 offset1:204
    ds_read_b128 a[0:3], v91 offset:0
    ds_read_b128 a[4:7], v91 offset:32
    ds_read_b128 a[8:11], v91 offset:64
    ds_read_b128 a[12:15], v91 offset:96
    ds_read_b128 a[16:19], v91 offset:128
    ds_read_b128 a[20:23], v91 offset:160
    ds_read_b128 a[24:27], v91 offset:192
    ds_read_b128 a[28:31], v91 offset:224
    v_pk_mul_f32 v[68:69], v[52:53], v[32:33] op_sel:[0,0] op_sel_hi:[0,1]
    v_pk_mul_f32 v[70:71], v[54:55], v[32:33] op_sel:[0,0] op_sel_hi:[0,1]
    v_pk_mul_f32 v[72:73], v[56:57], v[32:33] op_sel:[0,0] op_sel_hi:[0,1]
    v_pk_mul_f32 v[74:75], v[58:59], v[32:33] op_sel:[0,0] op_sel_hi:[0,1]
    v_pk_fma_f32 v[60:61], v[52:53], v[32:33], v[68:69] op_sel:[1,1,0] op_sel_hi:[1,0,1] neg_lo:[1,0,0]
    v_pk_fma_f32 v[62:63], v[54:55], v[32:33], v[70:71] op_sel:[1,1,0] op_sel_hi:[1,0,1] neg_lo:[1,0,0]
    v_pk_fma_f32 v[64:65], v[56:57], v[32:33], v[72:73] op_sel:[1,1,0] op_sel_hi:[1,0,1] neg_lo:[1,0,0]
    v_pk_fma_f32 v[66:67], v[58:59], v[32:33], v[74:75] op_sel:[1,1,0] op_sel_hi:[1,0,1] neg_lo:[1,0,0]
    v_cvt_pk_bf16_f32 v78, v52, -v53
    v_cvt_pk_bf16_f32 v79, v54, -v55
    ds_write2_b32 v82, v78, v79 offset0:0 offset1:68
    v_cvt_pk_bf16_f32 v80, v56, -v57
    v_cvt_pk_bf16_f32 v81, v58, -v59
    ds_write2_b32 v82, v80, v81 offset0:136 offset1:204
    v_pk_mul_f32 v[68:69], v[60:61], v[32:33] op_sel:[0,0] op_sel_hi:[0,1]
    v_pk_mul_f32 v[70:71], v[62:63], v[32:33] op_sel:[0,0] op_sel_hi:[0,1]
    v_pk_mul_f32 v[72:73], v[64:65], v[32:33] op_sel:[0,0] op_sel_hi:[0,1]
    v_pk_mul_f32 v[74:75], v[66:67], v[32:33] op_sel:[0,0] op_sel_hi:[0,1]
    v_pk_fma_f32 v[52:53], v[60:61], v[32:33], v[68:69] op_sel:[1,1,0] op_sel_hi:[1,0,1] neg_lo:[1,0,0]
    v_pk_fma_f32 v[54:55], v[62:63], v[32:33], v[70:71] op_sel:[1,1,0] op_sel_hi:[1,0,1] neg_lo:[1,0,0]
    v_pk_fma_f32 v[56:57], v[64:65], v[32:33], v[72:73] op_sel:[1,1,0] op_sel_hi:[1,0,1] neg_lo:[1,0,0]
    v_pk_fma_f32 v[58:59], v[66:67], v[32:33], v[74:75] op_sel:[1,1,0] op_sel_hi:[1,0,1] neg_lo:[1,0,0]
    v_cvt_pk_bf16_f32 v78, v60, -v61
    v_cvt_pk_bf16_f32 v79, v62, -v63
    ds_write2_b32 v83, v78, v79 offset0:0 offset1:68
    v_cvt_pk_bf16_f32 v80, v64, -v65
    v_cvt_pk_bf16_f32 v81, v66, -v67
    ds_write2_b32 v83, v80, v81 offset0:136 offset1:204
    v_pk_mul_f32 v[68:69], v[52:53], v[32:33] op_sel:[0,0] op_sel_hi:[0,1]
    v_pk_mul_f32 v[70:71], v[54:55], v[32:33] op_sel:[0,0] op_sel_hi:[0,1]
    v_pk_mul_f32 v[72:73], v[56:57], v[32:33] op_sel:[0,0] op_sel_hi:[0,1]
    v_pk_mul_f32 v[74:75], v[58:59], v[32:33] op_sel:[0,0] op_sel_hi:[0,1]
    v_pk_fma_f32 v[60:61], v[52:53], v[32:33], v[68:69] op_sel:[1,1,0] op_sel_hi:[1,0,1] neg_lo:[1,0,0]
    v_pk_fma_f32 v[62:63], v[54:55], v[32:33], v[70:71] op_sel:[1,1,0] op_sel_hi:[1,0,1] neg_lo:[1,0,0]
    v_pk_fma_f32 v[64:65], v[56:57], v[32:33], v[72:73] op_sel:[1,1,0] op_sel_hi:[1,0,1] neg_lo:[1,0,0]
    v_pk_fma_f32 v[66:67], v[58:59], v[32:33], v[74:75] op_sel:[1,1,0] op_sel_hi:[1,0,1] neg_lo:[1,0,0]
    v_cvt_pk_bf16_f32 v78, v52, -v53
    v_cvt_pk_bf16_f32 v79, v54, -v55
    ds_write2_b32 v84, v78, v79 offset0:0 offset1:68
    v_cvt_pk_bf16_f32 v80, v56, -v57
    v_cvt_pk_bf16_f32 v81, v58, -v59
    ds_write2_b32 v84, v80, v81 offset0:136 offset1:204
    v_pk_mul_f32 v[68:69], v[60:61], v[32:33] op_sel:[0,0] op_sel_hi:[0,1]
    v_pk_mul_f32 v[70:71], v[62:63], v[32:33] op_sel:[0,0] op_sel_hi:[0,1]
    v_pk_mul_f32 v[72:73], v[64:65], v[32:33] op_sel:[0,0] op_sel_hi:[0,1]
    v_pk_mul_f32 v[74:75], v[66:67], v[32:33] op_sel:[0,0] op_sel_hi:[0,1]
    v_pk_fma_f32 v[52:53], v[60:61], v[32:33], v[68:69] op_sel:[1,1,0] op_sel_hi:[1,0,1] neg_lo:[1,0,0]
    v_pk_fma_f32 v[54:55], v[62:63], v[32:33], v[70:71] op_sel:[1,1,0] op_sel_hi:[1,0,1] neg_lo:[1,0,0]
    v_pk_fma_f32 v[56:57], v[64:65], v[32:33], v[72:73] op_sel:[1,1,0] op_sel_hi:[1,0,1] neg_lo:[1,0,0]
    v_pk_fma_f32 v[58:59], v[66:67], v[32:33], v[74:75] op_sel:[1,1,0] op_sel_hi:[1,0,1] neg_lo:[1,0,0]
    v_cvt_pk_bf16_f32 v78, v60, -v61
    v_cvt_pk_bf16_f32 v79, v62, -v63
    ds_write2_b32 v85, v78, v79 offset0:0 offset1:68
    v_cvt_pk_bf16_f32 v80, v64, -v65
    v_cvt_pk_bf16_f32 v81, v66, -v67
    ds_write2_b32 v85, v80, v81 offset0:136 offset1:204
    v_pk_mul_f32 v[68:69], v[52:53], v[32:33] op_sel:[0,0] op_sel_hi:[0,1]
    v_pk_mul_f32 v[70:71], v[54:55], v[32:33] op_sel:[0,0] op_sel_hi:[0,1]
    v_pk_mul_f32 v[72:73], v[56:57], v[32:33] op_sel:[0,0] op_sel_hi:[0,1]
    v_pk_mul_f32 v[74:75], v[58:59], v[32:33] op_sel:[0,0] op_sel_hi:[0,1]
    v_pk_fma_f32 v[60:61], v[52:53], v[32:33], v[68:69] op_sel:[1,1,0] op_sel_hi:[1,0,1] neg_lo:[1,0,0]
    v_pk_fma_f32 v[62:63], v[54:55], v[32:33], v[70:71] op_sel:[1,1,0] op_sel_hi:[1,0,1] neg_lo:[1,0,0]
    v_pk_fma_f32 v[64:65], v[56:57], v[32:33], v[72:73] op_sel:[1,1,0] op_sel_hi:[1,0,1] neg_lo:[1,0,0]
    v_pk_fma_f32 v[66:67], v[58:59], v[32:33], v[74:75] op_sel:[1,1,0] op_sel_hi:[1,0,1] neg_lo:[1,0,0]
    v_cvt_pk_bf16_f32 v78, v52, -v53
    v_cvt_pk_bf16_f32 v79, v54, -v55
    ds_write2_b32 v86, v78, v79 offset0:0 offset1:68
    v_cvt_pk_bf16_f32 v80, v56, -v57
    v_cvt_pk_bf16_f32 v81, v58, -v59
    ds_write2_b32 v86, v80, v81 offset0:136 offset1:204
    v_pk_mul_f32 v[68:69], v[60:61], v[32:33] op_sel:[0,0] op_sel_hi:[0,1]
    v_pk_mul_f32 v[70:71], v[62:63], v[32:33] op_sel:[0,0] op_sel_hi:[0,1]
    v_pk_mul_f32 v[72:73], v[64:65], v[32:33] op_sel:[0,0] op_sel_hi:[0,1]
    v_pk_mul_f32 v[74:75], v[66:67], v[32:33] op_sel:[0,0] op_sel_hi:[0,1]
    v_pk_fma_f32 v[52:53], v[60:61], v[32:33], v[68:69] op_sel:[1,1,0] op_sel_hi:[1,0,1] neg_lo:[1,0,0]
    v_pk_fma_f32 v[54:55], v[62:63], v[32:33], v[70:71] op_sel:[1,1,0] op_sel_hi:[1,0,1] neg_lo:[1,0,0]
    v_pk_fma_f32 v[56:57], v[64:65], v[32:33], v[72:73] op_sel:[1,1,0] op_sel_hi:[1,0,1] neg_lo:[1,0,0]
    v_pk_fma_f32 v[58:59], v[66:67], v[32:33], v[74:75] op_sel:[1,1,0] op_sel_hi:[1,0,1] neg_lo:[1,0,0]
    v_cvt_pk_bf16_f32 v78, v60, -v61
    v_cvt_pk_bf16_f32 v79, v62, -v63
    ds_write2_b32 v87, v78, v79 offset0:0 offset1:68
    v_cvt_pk_bf16_f32 v80, v64, -v65
    v_cvt_pk_bf16_f32 v81, v66, -v67
    ds_write2_b32 v87, v80, v81 offset0:136 offset1:204
    v_pk_mul_f32 v[68:69], v[52:53], v[32:33] op_sel:[0,0] op_sel_hi:[0,1]
    v_pk_mul_f32 v[70:71], v[54:55], v[32:33] op_sel:[0,0] op_sel_hi:[0,1]
    v_pk_mul_f32 v[72:73], v[56:57], v[32:33] op_sel:[0,0] op_sel_hi:[0,1]
    v_pk_mul_f32 v[74:75], v[58:59], v[32:33] op_sel:[0,0] op_sel_hi:[0,1]
    v_pk_fma_f32 v[60:61], v[52:53], v[32:33], v[68:69] op_sel:[1,1,0] op_sel_hi:[1,0,1] neg_lo:[1,0,0]
    v_pk_fma_f32 v[62:63], v[54:55], v[32:33], v[70:71] op_sel:[1,1,0] op_sel_hi:[1,0,1] neg_lo:[1,0,0]
    v_pk_fma_f32 v[64:65], v[56:57], v[32:33], v[72:73] op_sel:[1,1,0] op_sel_hi:[1,0,1] neg_lo:[1,0,0]
    v_pk_fma_f32 v[66:67], v[58:59], v[32:33], v[74:75] op_sel:[1,1,0] op_sel_hi:[1,0,1] neg_lo:[1,0,0]
    v_cvt_pk_bf16_f32 v78, v52, -v53
    v_cvt_pk_bf16_f32 v79, v54, -v55
    ds_write2_b32 v88, v78, v79 offset0:0 offset1:68
    v_cvt_pk_bf16_f32 v80, v56, -v57
    v_cvt_pk_bf16_f32 v81, v58, -v59
    ds_write2_b32 v88, v80, v81 offset0:136 offset1:204
    v_cvt_pk_bf16_f32 v78, v60, -v61
    v_cvt_pk_bf16_f32 v79, v62, -v63
    ds_write2_b32 v89, v78, v79 offset0:0 offset1:68
    v_cvt_pk_bf16_f32 v80, v64, -v65
    v_cvt_pk_bf16_f32 v81, v66, -v67
    ds_write2_b32 v89, v80, v81 offset0:136 offset1:204
    ds_read_b128 a[32:35], v90 offset:0
    ds_read_b128 a[36:39], v90 offset:32
    ds_read_b128 a[40:43], v90 offset:64
    ds_read_b128 a[44:47], v90 offset:96
    ds_read_b128 a[48:51], v90 offset:128
    ds_read_b128 a[52:55], v90 offset:160
    ds_read_b128 a[56:59], v90 offset:192
    ds_read_b128 a[60:63], v90 offset:224
    v_lshlrev_b32 v2, 4, v1
    v_add_u32 v3, s44, v2
    v_lshrrev_b32 v6, 4, v1
    v_lshrrev_b32 v7, 3, v1
    v_xor_b32 v6, v6, v7
    v_and_b32 v6, 1, v6
    v_cmp_eq_u32 vcc, 0, v6
    v_mov_b32 v7, 0x3f803f80
    s_nop 0
    v_cndmask_b32 v76, 0, v7, vcc
    v_mov_b32 v77, v76
    v_mov_b32 v78, v76
    v_mov_b32 v79, v76
    v_and_b32 v10, 31, v1
    v_lshrrev_b32 v11, 5, v1
    s_lshl_b32 s84, s73, 5
    v_add_u32 v6, s84, v10
    v_lshrrev_b32 v7, 1, v10
    v_and_b32 v7, 7, v7
    v_xor_b32 v7, v7, v11
    v_lshlrev_b32 v7, 4, v7
    v_lshl_add_u32 v7, v6, 7, v7
    v_xor_b32 v12, s84, v7
    v_xor_b32 v13, 32, v12
    v_xor_b32 v14, 64, v12
    v_xor_b32 v15, 96, v12
    s_waitcnt lgkmcnt(7)
    v_mfma_f32_32x32x16_bf16 v[92:107], a[0:3], a[32:35], 0
    s_waitcnt lgkmcnt(6)
    v_mfma_f32_32x32x16_bf16 v[92:107], a[4:7], a[36:39], v[92:107]
    s_waitcnt lgkmcnt(5)
    v_mfma_f32_32x32x16_bf16 v[92:107], a[8:11], a[40:43], v[92:107]
    s_waitcnt lgkmcnt(4)
    v_mfma_f32_32x32x16_bf16 v[92:107], a[12:15], a[44:47], v[92:107]
    s_waitcnt lgkmcnt(3)
    v_mfma_f32_32x32x16_bf16 v[92:107], a[16:19], a[48:51], v[92:107]
    s_waitcnt lgkmcnt(2)
    v_mfma_f32_32x32x16_bf16 v[92:107], a[20:23], a[52:55], v[92:107]
    s_waitcnt lgkmcnt(1)
    v_mfma_f32_32x32x16_bf16 v[92:107], a[24:27], a[56:59], v[92:107]
    s_waitcnt lgkmcnt(0)
    v_mfma_f32_32x32x16_bf16 v[92:107], a[28:31], a[60:63], v[92:107]
    s_nop 11
    ds_write_b128 v3, v[100:103] offset:0
    ds_write_b128 v3, v[104:107] offset:1024
    ds_write_b128 v3, v[92:95] offset:2048
    ds_write_b128 v3, v[96:99] offset:3072
    s_mul_i32 s90, s2, 5504
    s_mul_i32 s91, s70, 1408
    s_add_u32 s90, s90, s91
    v_lshlrev_b32 v114, 7, v1
    s_mov_b64 exec, 2047
    buffer_load_dword v124, v114, s[16:19], s90 offen
    s_mov_b64 exec, -1
    s_waitcnt lgkmcnt(0)
    s_barrier
    s_setprio 1
    ds_read_b64_tr_b16 v[80:81], v117 offset:0
    ds_read_b64_tr_b16 v[82:83], v117 offset:256
    ds_read_b64_tr_b16 v[84:85], v117 offset:2048
    ds_read_b64_tr_b16 v[86:87], v117 offset:2304
    ds_read_b64_tr_b16 v[88:89], v117 offset:4096
    ds_read_b64_tr_b16 v[90:91], v117 offset:4352
    ds_read_b128 a[0:3], v12 offset:0
    ds_read_b128 a[4:7], v13 offset:0
    ds_read_b128 a[8:11], v14 offset:0
    ds_read_b128 a[12:15], v15 offset:0
    ds_read_b64_tr_b16 v[92:93], v120 offset:0
    ds_read_b64_tr_b16 v[94:95], v120 offset:256
    ds_read_b64_tr_b16 v[96:97], v120 offset:2048
    ds_read_b64_tr_b16 v[98:99], v120 offset:2304
    ds_read_b64_tr_b16 v[100:101], v120 offset:4096
    ds_read_b64_tr_b16 v[102:103], v120 offset:4352
    s_waitcnt lgkmcnt(9)
    v_mfma_f32_32x32x16_bf16 v[16:31], v[80:83], a[0:3], 0
    ds_read_b64_tr_b16 v[104:105], v117 offset:12288
    ds_read_b64_tr_b16 v[106:107], v117 offset:12544
    ds_read_b128 a[16:19], v12 offset:8192
    ds_read_b128 a[20:23], v13 offset:8192
    v_mfma_f32_16x16x32_bf16 v[64:67], v[80:83], v[76:79], 0
    v_mfma_f32_32x32x16_bf16 v[32:47], v[84:87], a[0:3], 0
    ds_read_b64_tr_b16 v[108:109], v117 offset:14336
    ds_read_b64_tr_b16 v[110:111], v117 offset:14592
    ds_read_b128 a[24:27], v14 offset:8192
    v_mfma_f32_16x16x32_bf16 v[68:71], v[84:87], v[76:79], 0
    v_mfma_f32_32x32x16_bf16 v[48:63], v[88:91], a[0:3], 0
    ds_read_b64_tr_b16 v[112:113], v117 offset:16384
    s_waitcnt vmcnt(2)
    ds_read_b64_tr_b16 v[114:115], v117 offset:16640
    ds_read_b128 a[28:31], v15 offset:8192
    v_mfma_f32_16x16x32_bf16 v[72:75], v[88:91], v[76:79], 0
    s_waitcnt lgkmcnt(14)
    v_mfma_f32_32x32x16_bf16 v[16:31], v[92:95], a[4:7], v[16:31]
    ds_read_b64_tr_b16 v[80:81], v120 offset:12288
    ds_read_b64_tr_b16 v[82:83], v120 offset:12544
    ds_read_b128 a[32:35], v12 offset:16384
    ds_read_b128 a[36:39], v13 offset:16384
    s_waitcnt lgkmcnt(15)
    v_mfma_f32_32x32x16_bf16 v[32:47], v[96:99], a[4:7], v[32:47]
    ds_read_b64_tr_b16 v[84:85], v120 offset:14336
    ds_read_b64_tr_b16 v[86:87], v120 offset:14592
    ds_read_b128 a[40:43], v14 offset:16384
    s_waitcnt lgkmcnt(15)
    v_mfma_f32_32x32x16_bf16 v[48:63], v[100:103], a[4:7], v[48:63]
    ds_read_b64_tr_b16 v[88:89], v120 offset:16384
    ds_read_b64_tr_b16 v[90:91], v120 offset:16640
    ds_read_b128 a[44:47], v15 offset:16384
    s_waitcnt lgkmcnt(10)
    s_barrier
    v_mfma_f32_32x32x16_bf16 v[16:31], v[104:107], a[8:11], v[16:31]
    ds_read_b64_tr_b16 v[92:93], v117 offset:24576
    ds_read_b64_tr_b16 v[94:95], v117 offset:24832
    ds_read_b128 a[48:51], v12 offset:24576
    ds_read_b128 a[52:55], v13 offset:24576
    v_mfma_f32_16x16x32_bf16 v[64:67], v[104:107], v[76:79], v[64:67]
    v_mfma_f32_32x32x16_bf16 v[32:47], v[108:111], a[8:11], v[32:47]
    ds_read_b64_tr_b16 v[96:97], v117 offset:26624
    ds_read_b64_tr_b16 v[98:99], v117 offset:26880
    ds_read_b128 a[56:59], v14 offset:24576
    v_mfma_f32_16x16x32_bf16 v[68:71], v[108:111], v[76:79], v[68:71]
    v_mfma_f32_32x32x16_bf16 v[48:63], v[112:115], a[8:11], v[48:63]
    ds_read_b64_tr_b16 v[100:101], v117 offset:28672
    ds_read_b64_tr_b16 v[102:103], v117 offset:28928
    ds_read_b128 a[60:63], v15 offset:24576
    v_mfma_f32_16x16x32_bf16 v[72:75], v[112:115], v[76:79], v[72:75]
    s_waitcnt lgkmcnt(15)
    v_mfma_f32_32x32x16_bf16 v[16:31], v[80:83], a[12:15], v[16:31]
    ds_read_b64_tr_b16 v[104:105], v120 offset:24576
    ds_read_b64_tr_b16 v[106:107], v120 offset:24832
    ds_read_b128 a[64:67], v12 offset:32768
    ds_read_b128 a[68:71], v13 offset:32768
    s_waitcnt lgkmcnt(15)
    v_mfma_f32_32x32x16_bf16 v[32:47], v[84:87], a[12:15], v[32:47]
    ds_read_b64_tr_b16 v[108:109], v120 offset:26624
    ds_read_b64_tr_b16 v[110:111], v120 offset:26880
    ds_read_b128 a[72:75], v14 offset:32768
    v_mfma_f32_32x32x16_bf16 v[48:63], v[88:91], a[12:15], v[48:63]
    ds_read_b64_tr_b16 v[112:113], v120 offset:28672
    ds_read_b64_tr_b16 v[114:115], v120 offset:28928
    ds_read_b128 a[76:79], v15 offset:32768
    s_waitcnt lgkmcnt(10)
    s_barrier
    v_mfma_f32_32x32x16_bf16 v[16:31], v[92:95], a[16:19], v[16:31]
    ds_read_b64_tr_b16 v[80:81], v117 offset:36864
    ds_read_b64_tr_b16 v[82:83], v117 offset:37120
    ds_read_b128 a[80:83], v12 offset:40960
    ds_read_b128 a[84:87], v13 offset:40960
    v_mfma_f32_16x16x32_bf16 v[64:67], v[92:95], v[76:79], v[64:67]
    v_mfma_f32_32x32x16_bf16 v[32:47], v[96:99], a[16:19], v[32:47]
    ds_read_b64_tr_b16 v[84:85], v117 offset:38912
    ds_read_b64_tr_b16 v[86:87], v117 offset:39168
    ds_read_b128 a[88:91], v14 offset:40960
    v_mfma_f32_16x16x32_bf16 v[68:71], v[96:99], v[76:79], v[68:71]
    v_mfma_f32_32x32x16_bf16 v[48:63], v[100:103], a[16:19], v[48:63]
    ds_read_b64_tr_b16 v[88:89], v117 offset:40960
    ds_read_b64_tr_b16 v[90:91], v117 offset:41216
    ds_read_b128 a[92:95], v15 offset:40960
    v_mfma_f32_16x16x32_bf16 v[72:75], v[100:103], v[76:79], v[72:75]
    s_waitcnt lgkmcnt(15)
    v_mfma_f32_32x32x16_bf16 v[16:31], v[104:107], a[20:23], v[16:31]
    ds_read_b64_tr_b16 v[92:93], v120 offset:36864
    ds_read_b64_tr_b16 v[94:95], v120 offset:37120
    ds_read_b128 a[96:99], v12 offset:49152
    ds_read_b128 a[100:103], v13 offset:49152
    s_waitcnt lgkmcnt(15)
    v_mfma_f32_32x32x16_bf16 v[32:47], v[108:111], a[20:23], v[32:47]
    ds_read_b64_tr_b16 v[96:97], v120 offset:38912
    ds_read_b64_tr_b16 v[98:99], v120 offset:39168
    ds_read_b128 a[104:107], v14 offset:49152
    v_mfma_f32_32x32x16_bf16 v[48:63], v[112:115], a[20:23], v[48:63]
    ds_read_b64_tr_b16 v[100:101], v120 offset:40960
    ds_read_b64_tr_b16 v[102:103], v120 offset:41216
    ds_read_b128 a[108:111], v15 offset:49152
    s_waitcnt lgkmcnt(10)
    s_barrier
    v_mfma_f32_32x32x16_bf16 v[16:31], v[80:83], a[24:27], v[16:31]
    ds_read_b64_tr_b16 v[104:105], v117 offset:0
    ds_read_b64_tr_b16 v[106:107], v117 offset:256
    ds_read_b128 a[112:115], v12 offset:57344
    ds_read_b128 a[116:119], v13 offset:57344
    v_mfma_f32_16x16x32_bf16 v[64:67], v[80:83], v[76:79], v[64:67]
    v_mfma_f32_32x32x16_bf16 v[32:47], v[84:87], a[24:27], v[32:47]
    ds_read_b64_tr_b16 v[108:109], v117 offset:2048
    ds_read_b64_tr_b16 v[110:111], v117 offset:2304
    ds_read_b128 a[120:123], v14 offset:57344
    v_mfma_f32_16x16x32_bf16 v[68:71], v[84:87], v[76:79], v[68:71]
    v_mfma_f32_32x32x16_bf16 v[48:63], v[88:91], a[24:27], v[48:63]
    ds_read_b64_tr_b16 v[112:113], v117 offset:4096
    ds_read_b64_tr_b16 v[114:115], v117 offset:4352
    ds_read_b128 a[124:127], v15 offset:57344
    v_mfma_f32_16x16x32_bf16 v[72:75], v[88:91], v[76:79], v[72:75]
    s_waitcnt lgkmcnt(15)
    v_mfma_f32_32x32x16_bf16 v[16:31], v[92:95], a[28:31], v[16:31]
    ds_read_b64_tr_b16 v[80:81], v120 offset:0
    ds_read_b64_tr_b16 v[82:83], v120 offset:256
    s_waitcnt lgkmcnt(15)
    v_mfma_f32_32x32x16_bf16 v[32:47], v[96:99], a[28:31], v[32:47]
    ds_read_b64_tr_b16 v[84:85], v120 offset:2048
    ds_read_b64_tr_b16 v[86:87], v120 offset:2304
    s_waitcnt lgkmcnt(15)
    v_mfma_f32_32x32x16_bf16 v[48:63], v[100:103], a[28:31], v[48:63]
    ds_read_b64_tr_b16 v[88:89], v120 offset:4096
    ds_read_b64_tr_b16 v[90:91], v120 offset:4352
    s_waitcnt lgkmcnt(6)
    s_barrier
    v_mfma_f32_32x32x16_bf16 v[16:31], v[104:107], a[32:35], v[16:31]
    ds_read_b64_tr_b16 v[92:93], v116 offset:0
    ds_read_b64_tr_b16 v[94:95], v116 offset:256
    v_mfma_f32_16x16x32_bf16 v[64:67], v[104:107], v[76:79], v[64:67]
    v_mfma_f32_32x32x16_bf16 v[32:47], v[108:111], a[32:35], v[32:47]
    ds_read_b64_tr_b16 v[96:97], v116 offset:2048
    ds_read_b64_tr_b16 v[98:99], v116 offset:2304
    v_mfma_f32_16x16x32_bf16 v[68:71], v[108:111], v[76:79], v[68:71]
    v_mfma_f32_32x32x16_bf16 v[48:63], v[112:115], a[32:35], v[48:63]
    ds_read_b64_tr_b16 v[100:101], v116 offset:4096
    ds_read_b64_tr_b16 v[102:103], v116 offset:4352
    v_mfma_f32_16x16x32_bf16 v[72:75], v[112:115], v[76:79], v[72:75]
    s_waitcnt lgkmcnt(10)
    v_mfma_f32_32x32x16_bf16 v[16:31], v[80:83], a[36:39], v[16:31]
    ds_read_b64_tr_b16 v[104:105], v119 offset:0
    ds_read_b64_tr_b16 v[106:107], v119 offset:256
    s_waitcnt lgkmcnt(10)
    v_mfma_f32_32x32x16_bf16 v[32:47], v[84:87], a[36:39], v[32:47]
    ds_read_b64_tr_b16 v[108:109], v119 offset:2048
    ds_read_b64_tr_b16 v[110:111], v119 offset:2304
    s_waitcnt lgkmcnt(10)
    v_mfma_f32_32x32x16_bf16 v[48:63], v[88:91], a[36:39], v[48:63]
    ds_read_b64_tr_b16 v[112:113], v119 offset:4096
    ds_read_b64_tr_b16 v[114:115], v119 offset:4352
    s_barrier
    s_waitcnt lgkmcnt(10)
    v_mfma_f32_32x32x16_bf16 v[16:31], v[92:95], a[40:43], v[16:31]
    ds_read_b64_tr_b16 v[80:81], v117 offset:12288
    ds_read_b64_tr_b16 v[82:83], v117 offset:12544
    v_mfma_f32_16x16x32_bf16 v[64:67], v[92:95], v[76:79], v[64:67]
    s_waitcnt lgkmcnt(10)
    v_mfma_f32_32x32x16_bf16 v[32:47], v[96:99], a[40:43], v[32:47]
    ds_read_b64_tr_b16 v[84:85], v117 offset:14336
    ds_read_b64_tr_b16 v[86:87], v117 offset:14592
    v_mfma_f32_16x16x32_bf16 v[68:71], v[96:99], v[76:79], v[68:71]
    s_waitcnt lgkmcnt(10)
    v_mfma_f32_32x32x16_bf16 v[48:63], v[100:103], a[40:43], v[48:63]
    ds_read_b64_tr_b16 v[88:89], v117 offset:16384
    ds_read_b64_tr_b16 v[90:91], v117 offset:16640
    v_mfma_f32_16x16x32_bf16 v[72:75], v[100:103], v[76:79], v[72:75]
    s_waitcnt lgkmcnt(10)
    v_mfma_f32_32x32x16_bf16 v[16:31], v[104:107], a[44:47], v[16:31]
    ds_read_b64_tr_b16 v[92:93], v120 offset:12288
    ds_read_b64_tr_b16 v[94:95], v120 offset:12544
    s_waitcnt lgkmcnt(10)
    v_mfma_f32_32x32x16_bf16 v[32:47], v[108:111], a[44:47], v[32:47]
    ds_read_b64_tr_b16 v[96:97], v120 offset:14336
    ds_read_b64_tr_b16 v[98:99], v120 offset:14592
    s_waitcnt lgkmcnt(10)
    v_mfma_f32_32x32x16_bf16 v[48:63], v[112:115], a[44:47], v[48:63]
    ds_read_b64_tr_b16 v[100:101], v120 offset:16384
    ds_read_b64_tr_b16 v[102:103], v120 offset:16640
    s_barrier
    s_waitcnt lgkmcnt(10)
    v_mfma_f32_32x32x16_bf16 v[16:31], v[80:83], a[48:51], v[16:31]
    ds_read_b64_tr_b16 v[104:105], v116 offset:12288
    ds_read_b64_tr_b16 v[106:107], v116 offset:12544
    v_mfma_f32_16x16x32_bf16 v[64:67], v[80:83], v[76:79], v[64:67]
    s_waitcnt lgkmcnt(10)
    v_mfma_f32_32x32x16_bf16 v[32:47], v[84:87], a[48:51], v[32:47]
    ds_read_b64_tr_b16 v[108:109], v116 offset:14336
    ds_read_b64_tr_b16 v[110:111], v116 offset:14592
    v_mfma_f32_16x16x32_bf16 v[68:71], v[84:87], v[76:79], v[68:71]
    s_waitcnt lgkmcnt(10)
    v_mfma_f32_32x32x16_bf16 v[48:63], v[88:91], a[48:51], v[48:63]
    ds_read_b64_tr_b16 v[112:113], v116 offset:16384
    ds_read_b64_tr_b16 v[114:115], v116 offset:16640
    v_mfma_f32_16x16x32_bf16 v[72:75], v[88:91], v[76:79], v[72:75]
    s_waitcnt lgkmcnt(10)
    v_mfma_f32_32x32x16_bf16 v[16:31], v[92:95], a[52:55], v[16:31]
    ds_read_b64_tr_b16 v[80:81], v119 offset:12288
    ds_read_b64_tr_b16 v[82:83], v119 offset:12544
    s_waitcnt lgkmcnt(10)
    v_mfma_f32_32x32x16_bf16 v[32:47], v[96:99], a[52:55], v[32:47]
    ds_read_b64_tr_b16 v[84:85], v119 offset:14336
    ds_read_b64_tr_b16 v[86:87], v119 offset:14592
    s_waitcnt lgkmcnt(10)
    v_mfma_f32_32x32x16_bf16 v[48:63], v[100:103], a[52:55], v[48:63]
    ds_read_b64_tr_b16 v[88:89], v119 offset:16384
    ds_read_b64_tr_b16 v[90:91], v119 offset:16640
    s_barrier
    s_waitcnt lgkmcnt(10)
    v_mfma_f32_32x32x16_bf16 v[16:31], v[104:107], a[56:59], v[16:31]
    ds_read_b64_tr_b16 v[92:93], v117 offset:24576
    ds_read_b64_tr_b16 v[94:95], v117 offset:24832
    v_mfma_f32_16x16x32_bf16 v[64:67], v[104:107], v[76:79], v[64:67]
    s_waitcnt lgkmcnt(10)
    v_mfma_f32_32x32x16_bf16 v[32:47], v[108:111], a[56:59], v[32:47]
    ds_read_b64_tr_b16 v[96:97], v117 offset:26624
    ds_read_b64_tr_b16 v[98:99], v117 offset:26880
    v_mfma_f32_16x16x32_bf16 v[68:71], v[108:111], v[76:79], v[68:71]
    s_waitcnt lgkmcnt(10)
    v_mfma_f32_32x32x16_bf16 v[48:63], v[112:115], a[56:59], v[48:63]
    ds_read_b64_tr_b16 v[100:101], v117 offset:28672
    ds_read_b64_tr_b16 v[102:103], v117 offset:28928
    v_mfma_f32_16x16x32_bf16 v[72:75], v[112:115], v[76:79], v[72:75]
    s_waitcnt lgkmcnt(10)
    v_mfma_f32_32x32x16_bf16 v[16:31], v[80:83], a[60:63], v[16:31]
    ds_read_b64_tr_b16 v[104:105], v120 offset:24576
    ds_read_b64_tr_b16 v[106:107], v120 offset:24832
    s_waitcnt lgkmcnt(10)
    v_mfma_f32_32x32x16_bf16 v[32:47], v[84:87], a[60:63], v[32:47]
    ds_read_b64_tr_b16 v[108:109], v120 offset:26624
    ds_read_b64_tr_b16 v[110:111], v120 offset:26880
    s_waitcnt lgkmcnt(10)
    v_mfma_f32_32x32x16_bf16 v[48:63], v[88:91], a[60:63], v[48:63]
    ds_read_b64_tr_b16 v[112:113], v120 offset:28672
    ds_read_b64_tr_b16 v[114:115], v120 offset:28928
    s_barrier
    s_waitcnt lgkmcnt(10)
    v_mfma_f32_32x32x16_bf16 v[16:31], v[92:95], a[64:67], v[16:31]
    ds_read_b64_tr_b16 v[80:81], v116 offset:24576
    ds_read_b64_tr_b16 v[82:83], v116 offset:24832
    v_mfma_f32_16x16x32_bf16 v[64:67], v[92:95], v[76:79], v[64:67]
    s_waitcnt lgkmcnt(10)
    v_mfma_f32_32x32x16_bf16 v[32:47], v[96:99], a[64:67], v[32:47]
    ds_read_b64_tr_b16 v[84:85], v116 offset:26624
    ds_read_b64_tr_b16 v[86:87], v116 offset:26880
    v_mfma_f32_16x16x32_bf16 v[68:71], v[96:99], v[76:79], v[68:71]
    s_waitcnt lgkmcnt(10)
    v_mfma_f32_32x32x16_bf16 v[48:63], v[100:103], a[64:67], v[48:63]
    ds_read_b64_tr_b16 v[88:89], v116 offset:28672
    ds_read_b64_tr_b16 v[90:91], v116 offset:28928
    v_mfma_f32_16x16x32_bf16 v[72:75], v[100:103], v[76:79], v[72:75]
    s_waitcnt lgkmcnt(10)
    v_mfma_f32_32x32x16_bf16 v[16:31], v[104:107], a[68:71], v[16:31]
    ds_read_b64_tr_b16 v[92:93], v119 offset:24576
    ds_read_b64_tr_b16 v[94:95], v119 offset:24832
    s_waitcnt lgkmcnt(10)
    v_mfma_f32_32x32x16_bf16 v[32:47], v[108:111], a[68:71], v[32:47]
    ds_read_b64_tr_b16 v[96:97], v119 offset:26624
    ds_read_b64_tr_b16 v[98:99], v119 offset:26880
    s_waitcnt lgkmcnt(10)
    v_mfma_f32_32x32x16_bf16 v[48:63], v[112:115], a[68:71], v[48:63]
    ds_read_b64_tr_b16 v[100:101], v119 offset:28672
    ds_read_b64_tr_b16 v[102:103], v119 offset:28928
    s_barrier
    s_waitcnt lgkmcnt(10)
    v_mfma_f32_32x32x16_bf16 v[16:31], v[80:83], a[72:75], v[16:31]
    ds_read_b64_tr_b16 v[104:105], v117 offset:36864
    ds_read_b64_tr_b16 v[106:107], v117 offset:37120
    v_mfma_f32_16x16x32_bf16 v[64:67], v[80:83], v[76:79], v[64:67]
    s_waitcnt lgkmcnt(10)
    v_mfma_f32_32x32x16_bf16 v[32:47], v[84:87], a[72:75], v[32:47]
    ds_read_b64_tr_b16 v[108:109], v117 offset:38912
    ds_read_b64_tr_b16 v[110:111], v117 offset:39168
    v_mfma_f32_16x16x32_bf16 v[68:71], v[84:87], v[76:79], v[68:71]
    s_waitcnt lgkmcnt(10)
    v_mfma_f32_32x32x16_bf16 v[48:63], v[88:91], a[72:75], v[48:63]
    ds_read_b64_tr_b16 v[112:113], v117 offset:40960
    ds_read_b64_tr_b16 v[114:115], v117 offset:41216
    v_mfma_f32_16x16x32_bf16 v[72:75], v[88:91], v[76:79], v[72:75]
    s_waitcnt lgkmcnt(10)
    v_mfma_f32_32x32x16_bf16 v[16:31], v[92:95], a[76:79], v[16:31]
    ds_read_b64_tr_b16 v[80:81], v120 offset:36864
    ds_read_b64_tr_b16 v[82:83], v120 offset:37120
    s_waitcnt lgkmcnt(10)
    v_mfma_f32_32x32x16_bf16 v[32:47], v[96:99], a[76:79], v[32:47]
    ds_read_b64_tr_b16 v[84:85], v120 offset:38912
    ds_read_b64_tr_b16 v[86:87], v120 offset:39168
    s_waitcnt lgkmcnt(10)
    v_mfma_f32_32x32x16_bf16 v[48:63], v[100:103], a[76:79], v[48:63]
    ds_read_b64_tr_b16 v[88:89], v120 offset:40960
    ds_read_b64_tr_b16 v[90:91], v120 offset:41216
    s_barrier
    s_waitcnt lgkmcnt(10)
    v_mfma_f32_32x32x16_bf16 v[16:31], v[104:107], a[80:83], v[16:31]
    ds_read_b64_tr_b16 v[92:93], v116 offset:36864
    ds_read_b64_tr_b16 v[94:95], v116 offset:37120
    v_mfma_f32_16x16x32_bf16 v[64:67], v[104:107], v[76:79], v[64:67]
    s_waitcnt lgkmcnt(10)
    v_mfma_f32_32x32x16_bf16 v[32:47], v[108:111], a[80:83], v[32:47]
    ds_read_b64_tr_b16 v[96:97], v116 offset:38912
    ds_read_b64_tr_b16 v[98:99], v116 offset:39168
    v_mfma_f32_16x16x32_bf16 v[68:71], v[108:111], v[76:79], v[68:71]
    s_waitcnt lgkmcnt(10)
    v_mfma_f32_32x32x16_bf16 v[48:63], v[112:115], a[80:83], v[48:63]
    ds_read_b64_tr_b16 v[100:101], v116 offset:40960
    ds_read_b64_tr_b16 v[102:103], v116 offset:41216
    v_mfma_f32_16x16x32_bf16 v[72:75], v[112:115], v[76:79], v[72:75]
    s_waitcnt lgkmcnt(10)
    v_mfma_f32_32x32x16_bf16 v[16:31], v[80:83], a[84:87], v[16:31]
    ds_read_b64_tr_b16 v[104:105], v119 offset:36864
    ds_read_b64_tr_b16 v[106:107], v119 offset:37120
    s_waitcnt lgkmcnt(10)
    v_mfma_f32_32x32x16_bf16 v[32:47], v[84:87], a[84:87], v[32:47]
    ds_read_b64_tr_b16 v[108:109], v119 offset:38912
    ds_read_b64_tr_b16 v[110:111], v119 offset:39168
    s_waitcnt lgkmcnt(10)
    v_mfma_f32_32x32x16_bf16 v[48:63], v[88:91], a[84:87], v[48:63]
    ds_read_b64_tr_b16 v[112:113], v119 offset:40960
    ds_read_b64_tr_b16 v[114:115], v119 offset:41216
    s_barrier
    s_waitcnt lgkmcnt(10)
    v_mfma_f32_32x32x16_bf16 v[16:31], v[92:95], a[88:91], v[16:31]
    ds_read_b64_tr_b16 v[80:81], v117 offset:0
    ds_read_b64_tr_b16 v[82:83], v117 offset:256
    v_lshrrev_b32 v4, 4, v1
    v_lshlrev_b32 v4, 4, v4
    v_and_b32 v5, 8, v1
    v_mfma_f32_16x16x32_bf16 v[64:67], v[92:95], v[76:79], v[64:67]
    s_waitcnt lgkmcnt(10)
    v_mfma_f32_32x32x16_bf16 v[32:47], v[96:99], a[88:91], v[32:47]
    ds_read_b64_tr_b16 v[84:85], v117 offset:2048
    ds_read_b64_tr_b16 v[86:87], v117 offset:2304
    v_lshl_add_u32 v4, v5, 3, v4
    s_mul_i32 s92, s74, 384
    s_mul_i32 s93, s73, 768
    v_mfma_f32_16x16x32_bf16 v[68:71], v[96:99], v[76:79], v[68:71]
    s_waitcnt lgkmcnt(10)
    v_mfma_f32_32x32x16_bf16 v[48:63], v[100:103], a[88:91], v[48:63]
    ds_read_b64_tr_b16 v[88:89], v117 offset:4096
    ds_read_b64_tr_b16 v[90:91], v117 offset:4352
    s_add_u32 s92, s92, s93
    s_add_u32 s92, s92, 160256
    v_add_u32 v8, s92, v4
    v_mfma_f32_16x16x32_bf16 v[72:75], v[100:103], v[76:79], v[72:75]
    s_waitcnt lgkmcnt(10)
    v_mfma_f32_32x32x16_bf16 v[16:31], v[104:107], a[92:95], v[16:31]
    ds_read_b64_tr_b16 v[92:93], v120 offset:0
    ds_read_b64_tr_b16 v[94:95], v120 offset:256
    v_and_b32 v6, 31, v1
    s_lshl_b32 s80, s73, 5
    v_add_u32 v6, s80, v6
    s_waitcnt lgkmcnt(10)
    v_mfma_f32_32x32x16_bf16 v[32:47], v[108:111], a[92:95], v[32:47]
    ds_read_b64_tr_b16 v[96:97], v120 offset:2048
    ds_read_b64_tr_b16 v[98:99], v120 offset:2304
    v_lshlrev_b32 v6, 2, v6
    v_add_u32 v6, 158720, v6
    v_mov_b32 v7, 162304
    s_waitcnt lgkmcnt(10)
    v_mfma_f32_32x32x16_bf16 v[48:63], v[112:115], a[92:95], v[48:63]
    ds_read_b64_tr_b16 v[100:101], v120 offset:4096
    ds_read_b64_tr_b16 v[102:103], v120 offset:4352
    s_lshl_b32 s88, s71, 1
    s_add_u32 s88, s88, s73
    s_mul_i32 s88, s88, 86
    s_barrier
    s_waitcnt lgkmcnt(10)
    v_mfma_f32_32x32x16_bf16 v[16:31], v[80:83], a[96:99], v[16:31]
    ds_read_b64_tr_b16 v[104:105], v116 offset:0
    ds_read_b64_tr_b16 v[106:107], v116 offset:256
    s_mul_i32 s89, s74, 3
    s_add_u32 s89, s89, s77
    s_lshl_b32 s89, s89, 1
    v_mfma_f32_16x16x32_bf16 v[64:67], v[80:83], v[76:79], v[64:67]
    s_waitcnt lgkmcnt(10)
    v_mfma_f32_32x32x16_bf16 v[32:47], v[84:87], a[96:99], v[32:47]
    ds_read_b64_tr_b16 v[108:109], v116 offset:2048
    ds_read_b64_tr_b16 v[110:111], v116 offset:2304
    s_add_u32 s88, s88, s89
    s_lshl_b32 s88, s88, 10
    s_add_u32 s88, s88, 4194304
    v_mfma_f32_16x16x32_bf16 v[68:71], v[84:87], v[76:79], v[68:71]
    s_waitcnt lgkmcnt(10)
    v_mfma_f32_32x32x16_bf16 v[48:63], v[88:91], a[96:99], v[48:63]
    ds_read_b64_tr_b16 v[112:113], v116 offset:4096
    ds_read_b64_tr_b16 v[114:115], v116 offset:4352
    s_mul_i32 s85, s74, 384
    s_add_u32 s85, s85, 159232
    v_mfma_f32_16x16x32_bf16 v[72:75], v[88:91], v[76:79], v[72:75]
    s_waitcnt lgkmcnt(10)
    v_mfma_f32_32x32x16_bf16 v[16:31], v[92:95], a[100:103], v[16:31]
    ds_read_b64_tr_b16 v[80:81], v119 offset:0
    ds_read_b64_tr_b16 v[82:83], v119 offset:256
    s_waitcnt lgkmcnt(10)
    v_mfma_f32_32x32x16_bf16 v[32:47], v[96:99], a[100:103], v[32:47]
    ds_read_b64_tr_b16 v[84:85], v119 offset:2048
    ds_read_b64_tr_b16 v[86:87], v119 offset:2304
    s_waitcnt lgkmcnt(10)
    v_mfma_f32_32x32x16_bf16 v[48:63], v[100:103], a[100:103], v[48:63]
    ds_read_b64_tr_b16 v[88:89], v119 offset:4096
    ds_read_b64_tr_b16 v[90:91], v119 offset:4352
    s_barrier
    s_waitcnt lgkmcnt(10)
    v_mfma_f32_32x32x16_bf16 v[16:31], v[104:107], a[104:107], v[16:31]
    ds_read_b64_tr_b16 v[92:93], v117 offset:12288
    ds_read_b64_tr_b16 v[94:95], v117 offset:12544
    v_mfma_f32_16x16x32_bf16 v[64:67], v[104:107], v[76:79], v[64:67]
    s_waitcnt lgkmcnt(10)
    v_mfma_f32_32x32x16_bf16 v[32:47], v[108:111], a[104:107], v[32:47]
    ds_read_b64_tr_b16 v[96:97], v117 offset:14336
    ds_read_b64_tr_b16 v[98:99], v117 offset:14592
    v_mfma_f32_16x16x32_bf16 v[68:71], v[108:111], v[76:79], v[68:71]
    s_waitcnt lgkmcnt(10)
    v_mfma_f32_32x32x16_bf16 v[48:63], v[112:115], a[104:107], v[48:63]
    ds_read_b64_tr_b16 v[100:101], v117 offset:16384
    ds_read_b64_tr_b16 v[102:103], v117 offset:16640
    v_mfma_f32_16x16x32_bf16 v[72:75], v[112:115], v[76:79], v[72:75]
    s_waitcnt lgkmcnt(10)
    v_mfma_f32_32x32x16_bf16 v[16:31], v[80:83], a[108:111], v[16:31]
    ds_read_b64_tr_b16 v[104:105], v120 offset:12288
    ds_read_b64_tr_b16 v[106:107], v120 offset:12544
    s_waitcnt lgkmcnt(10)
    v_mfma_f32_32x32x16_bf16 v[32:47], v[84:87], a[108:111], v[32:47]
    ds_read_b64_tr_b16 v[108:109], v120 offset:14336
    ds_read_b64_tr_b16 v[110:111], v120 offset:14592
    s_waitcnt lgkmcnt(10)
    v_mfma_f32_32x32x16_bf16 v[48:63], v[88:91], a[108:111], v[48:63]
    ds_read_b64_tr_b16 v[112:113], v120 offset:16384
    ds_read_b64_tr_b16 v[114:115], v120 offset:16640
    s_barrier
    s_waitcnt lgkmcnt(10)
    v_mfma_f32_32x32x16_bf16 v[16:31], v[92:95], a[112:115], v[16:31]
    ds_read_b64_tr_b16 v[80:81], v116 offset:12288
    ds_read_b64_tr_b16 v[82:83], v116 offset:12544
    v_mfma_f32_16x16x32_bf16 v[64:67], v[92:95], v[76:79], v[64:67]
    s_waitcnt lgkmcnt(10)
    v_mfma_f32_32x32x16_bf16 v[32:47], v[96:99], a[112:115], v[32:47]
    ds_read_b64_tr_b16 v[84:85], v116 offset:14336
    ds_read_b64_tr_b16 v[86:87], v116 offset:14592
    v_mfma_f32_16x16x32_bf16 v[68:71], v[96:99], v[76:79], v[68:71]
    s_waitcnt lgkmcnt(10)
    v_mfma_f32_32x32x16_bf16 v[48:63], v[100:103], a[112:115], v[48:63]
    ds_read_b64_tr_b16 v[88:89], v116 offset:16384
    ds_read_b64_tr_b16 v[90:91], v116 offset:16640
    v_mfma_f32_16x16x32_bf16 v[72:75], v[100:103], v[76:79], v[72:75]
    s_waitcnt lgkmcnt(10)
    v_mfma_f32_32x32x16_bf16 v[16:31], v[104:107], a[116:119], v[16:31]
    ds_read_b64_tr_b16 v[92:93], v119 offset:12288
    ds_read_b64_tr_b16 v[94:95], v119 offset:12544
    s_waitcnt lgkmcnt(10)
    v_mfma_f32_32x32x16_bf16 v[32:47], v[108:111], a[116:119], v[32:47]
    ds_read_b64_tr_b16 v[96:97], v119 offset:14336
    ds_read_b64_tr_b16 v[98:99], v119 offset:14592
    s_waitcnt lgkmcnt(10)
    v_mfma_f32_32x32x16_bf16 v[48:63], v[112:115], a[116:119], v[48:63]
    ds_read_b64_tr_b16 v[100:101], v119 offset:16384
    ds_read_b64_tr_b16 v[102:103], v119 offset:16640
    s_waitcnt lgkmcnt(10)
    v_mfma_f32_32x32x16_bf16 v[16:31], v[80:83], a[120:123], v[16:31]
    v_lshrrev_b32 v112, 5, v1
    v_lshlrev_b32 v112, 4, v112
    v_add_u32 v112, s85, v112
    v_lshlrev_b32 v113, 4, v1
    ds_read_b32 v9, v7
    v_mfma_f32_16x16x32_bf16 v[64:67], v[80:83], v[76:79], v[64:67]
    s_waitcnt lgkmcnt(9)
    v_mfma_f32_32x32x16_bf16 v[32:47], v[84:87], a[120:123], v[32:47]
    ds_read_b32 v122, v6
    s_waitcnt vmcnt(0)
    ds_read_b32 v124, v6 offset:256
    v_and_b32 v2, 15, v1
    v_lshrrev_b32 v3, 4, v1
    v_lshlrev_b32 v4, 5, v2
    v_mfma_f32_16x16x32_bf16 v[68:71], v[84:87], v[76:79], v[68:71]
    s_waitcnt lgkmcnt(9)
    v_mfma_f32_32x32x16_bf16 v[48:63], v[88:91], a[120:123], v[48:63]
    v_sub_u32 v4, 480, v4
    v_lshl_add_u32 v4, v3, 4, v4
    s_mul_i32 s82, s73, 4608
    s_lshl_b32 s83, s74, 8
    s_add_u32 s82, s82, s83
    v_mfma_f32_16x16x32_bf16 v[72:75], v[88:91], v[76:79], v[72:75]
    s_waitcnt lgkmcnt(7)
    v_mfma_f32_32x32x16_bf16 v[16:31], v[92:95], a[124:127], v[16:31]
    s_add_u32 s82, s82, 149504
    v_add_u32 v114, s82, v4
    v_add_u32 v5, 1, v2
    v_and_b32 v6, 3, v5
    v_mul_u32_u24 v6, 4160, v6
    s_mov_b32 exec_lo, 0x01010101
    s_mov_b32 exec_hi, 0x01010101
    ds_write_b128 v8, v[64:67] offset:0
    s_mov_b64 exec, -1
    s_waitcnt lgkmcnt(5)
    v_mfma_f32_32x32x16_bf16 v[32:47], v[96:99], a[124:127], v[32:47]
    v_lshrrev_b32 v5, 2, v5
    v_lshl_add_u32 v6, v5, 3, v6
    v_lshl_add_u32 v6, v3, 4, v6
    s_mul_i32 s80, s73, 16640
    s_add_u32 s80, s80, 114688
    s_mov_b32 exec_lo, 0x01010101
    s_mov_b32 exec_hi, 0x01010101
    ds_write_b128 v8, v[68:71] offset:128
    s_mov_b64 exec, -1
    s_waitcnt lgkmcnt(3)
    v_mfma_f32_32x32x16_bf16 v[48:63], v[100:103], a[124:127], v[48:63]
    s_add_u32 s83, s83, s80
    v_add_u32 v115, s83, v6
    s_mov_b32 exec_lo, 0x01010101
    s_mov_b32 exec_hi, 0x01010101
    ds_write_b128 v8, v[72:75] offset:256
    s_mov_b64 exec, -1
    s_waitcnt lgkmcnt(2)
    v_readfirstlane_b32 s75, v9
    s_waitcnt lgkmcnt(0)
    s_barrier
    ds_read_b128 v[88:91], v112 offset:1024
    ds_read_b128 v[80:83], v112 offset:0
    ds_read_b128 v[4:7], v112 offset:1792
    ds_read_b128 v[92:95], v112 offset:1056
    ds_read_b128 v[84:87], v112 offset:32
    ds_read_b128 v[8:11], v112 offset:1824
    ds_read_b128 v[104:107], v112 offset:1088
    ds_read_b128 v[96:99], v112 offset:64
    ds_read_b128 v[12:15], v112 offset:1856
    ds_read_b128 v[108:111], v112 offset:1120
    ds_read_b128 v[100:103], v112 offset:96
    ds_read_b128 v[116:119], v112 offset:1888
    s_waitcnt lgkmcnt(10)
    v_pk_fma_f32 v[80:81], v[88:89], v[124:125], v[80:81] op_sel:[0,0,0] op_sel_hi:[1,0,1]
    v_pk_fma_f32 v[82:83], v[90:91], v[124:125], v[82:83] op_sel:[0,0,0] op_sel_hi:[1,0,1]
    s_waitcnt lgkmcnt(7)
    v_pk_fma_f32 v[84:85], v[92:93], v[124:125], v[84:85] op_sel:[0,0,0] op_sel_hi:[1,0,1]
    v_pk_fma_f32 v[86:87], v[94:95], v[124:125], v[86:87] op_sel:[0,0,0] op_sel_hi:[1,0,1]
    v_pk_fma_f32 v[80:81], v[4:5], v[124:125], v[80:81] op_sel:[0,0,0] op_sel_hi:[1,0,1]
    v_pk_fma_f32 v[82:83], v[6:7], v[124:125], v[82:83] op_sel:[0,0,0] op_sel_hi:[1,0,1]
    s_waitcnt lgkmcnt(6)
    v_pk_fma_f32 v[84:85], v[8:9], v[124:125], v[84:85] op_sel:[0,0,0] op_sel_hi:[1,0,1]
    v_pk_fma_f32 v[86:87], v[10:11], v[124:125], v[86:87] op_sel:[0,0,0] op_sel_hi:[1,0,1]
    v_pk_fma_f32 v[80:81], v[16:17], v[122:123], v[80:81] op_sel:[0,0,0] op_sel_hi:[1,0,1]
    v_pk_fma_f32 v[82:83], v[18:19], v[122:123], v[82:83] op_sel:[0,0,0] op_sel_hi:[1,0,1]
    v_pk_fma_f32 v[84:85], v[20:21], v[122:123], v[84:85] op_sel:[0,0,0] op_sel_hi:[1,0,1]
    v_pk_fma_f32 v[86:87], v[22:23], v[122:123], v[86:87] op_sel:[0,0,0] op_sel_hi:[1,0,1]
    v_max_f32 v80, 0, v80
    v_max_f32 v81, 0, v81
    v_max_f32 v82, 0, v82
    v_max_f32 v83, 0, v83
    v_max_f32 v84, 0, v84
    v_max_f32 v85, 0, v85
    v_max_f32 v86, 0, v86
    v_max_f32 v87, 0, v87
    v_pk_mul_f32 v[80:81], v[80:81], v[80:81]
    v_pk_mul_f32 v[82:83], v[82:83], v[82:83]
    v_pk_mul_f32 v[84:85], v[84:85], v[84:85]
    v_pk_mul_f32 v[86:87], v[86:87], v[86:87]
    v_cvt_pk_bf16_f32 v64, v80, v81
    v_cvt_pk_bf16_f32 v65, v82, v83
    v_cvt_pk_bf16_f32 v66, v84, v85
    v_cvt_pk_bf16_f32 v67, v86, v87
    s_nop 0
    v_permlane32_swap_b32 v64, v66
    v_permlane32_swap_b32 v65, v67
    s_add_u32 s90, s88, 0
    buffer_store_dwordx4 v[64:67], v113, s[20:23], s90 offen sc1
    ds_read_b128 v[88:91], v112 offset:1152
    ds_read_b128 v[80:83], v112 offset:128
    ds_read_b128 v[4:7], v112 offset:1920
    ds_read_b128 v[92:95], v112 offset:1184
    ds_read_b128 v[84:87], v112 offset:160
    ds_read_b128 v[8:11], v112 offset:1952
    s_waitcnt lgkmcnt(10)
    v_pk_fma_f32 v[96:97], v[104:105], v[124:125], v[96:97] op_sel:[0,0,0] op_sel_hi:[1,0,1]
    v_pk_fma_f32 v[98:99], v[106:107], v[124:125], v[98:99] op_sel:[0,0,0] op_sel_hi:[1,0,1]
    s_waitcnt lgkmcnt(7)
    v_pk_fma_f32 v[100:101], v[108:109], v[124:125], v[100:101] op_sel:[0,0,0] op_sel_hi:[1,0,1]
    v_pk_fma_f32 v[102:103], v[110:111], v[124:125], v[102:103] op_sel:[0,0,0] op_sel_hi:[1,0,1]
    v_pk_fma_f32 v[96:97], v[12:13], v[124:125], v[96:97] op_sel:[0,0,0] op_sel_hi:[1,0,1]
    v_pk_fma_f32 v[98:99], v[14:15], v[124:125], v[98:99] op_sel:[0,0,0] op_sel_hi:[1,0,1]
    s_waitcnt lgkmcnt(6)
    v_pk_fma_f32 v[100:101], v[116:117], v[124:125], v[100:101] op_sel:[0,0,0] op_sel_hi:[1,0,1]
    v_pk_fma_f32 v[102:103], v[118:119], v[124:125], v[102:103] op_sel:[0,0,0] op_sel_hi:[1,0,1]
    v_pk_fma_f32 v[96:97], v[24:25], v[122:123], v[96:97] op_sel:[0,0,0] op_sel_hi:[1,0,1]
    v_pk_fma_f32 v[98:99], v[26:27], v[122:123], v[98:99] op_sel:[0,0,0] op_sel_hi:[1,0,1]
    v_pk_fma_f32 v[100:101], v[28:29], v[122:123], v[100:101] op_sel:[0,0,0] op_sel_hi:[1,0,1]
    v_pk_fma_f32 v[102:103], v[30:31], v[122:123], v[102:103] op_sel:[0,0,0] op_sel_hi:[1,0,1]
    v_max_f32 v96, 0, v96
    v_max_f32 v97, 0, v97
    v_max_f32 v98, 0, v98
    v_max_f32 v99, 0, v99
    v_max_f32 v100, 0, v100
    v_max_f32 v101, 0, v101
    v_max_f32 v102, 0, v102
    v_max_f32 v103, 0, v103
    v_pk_mul_f32 v[96:97], v[96:97], v[96:97]
    v_pk_mul_f32 v[98:99], v[98:99], v[98:99]
    v_pk_mul_f32 v[100:101], v[100:101], v[100:101]
    v_pk_mul_f32 v[102:103], v[102:103], v[102:103]
    v_cvt_pk_bf16_f32 v68, v96, v97
    v_cvt_pk_bf16_f32 v69, v98, v99
    v_cvt_pk_bf16_f32 v70, v100, v101
    v_cvt_pk_bf16_f32 v71, v102, v103
    s_nop 0
    v_permlane32_swap_b32 v68, v70
    v_permlane32_swap_b32 v69, v71
    s_add_u32 s90, s88, 1024
    buffer_store_dwordx4 v[68:71], v113, s[20:23], s90 offen sc1
    ds_read_b128 v[104:107], v112 offset:1216
    ds_read_b128 v[96:99], v112 offset:192
    ds_read_b128 v[12:15], v112 offset:1984
    ds_read_b128 v[108:111], v112 offset:1248
    ds_read_b128 v[100:103], v112 offset:224
    ds_read_b128 v[116:119], v112 offset:2016
    s_waitcnt lgkmcnt(10)
    v_pk_fma_f32 v[80:81], v[88:89], v[124:125], v[80:81] op_sel:[0,0,0] op_sel_hi:[1,0,1]
    v_pk_fma_f32 v[82:83], v[90:91], v[124:125], v[82:83] op_sel:[0,0,0] op_sel_hi:[1,0,1]
    s_waitcnt lgkmcnt(7)
    v_pk_fma_f32 v[84:85], v[92:93], v[124:125], v[84:85] op_sel:[0,0,0] op_sel_hi:[1,0,1]
    v_pk_fma_f32 v[86:87], v[94:95], v[124:125], v[86:87] op_sel:[0,0,0] op_sel_hi:[1,0,1]
    v_pk_fma_f32 v[80:81], v[4:5], v[124:125], v[80:81] op_sel:[0,0,0] op_sel_hi:[1,0,1]
    v_pk_fma_f32 v[82:83], v[6:7], v[124:125], v[82:83] op_sel:[0,0,0] op_sel_hi:[1,0,1]
    s_waitcnt lgkmcnt(6)
    v_pk_fma_f32 v[84:85], v[8:9], v[124:125], v[84:85] op_sel:[0,0,0] op_sel_hi:[1,0,1]
    v_pk_fma_f32 v[86:87], v[10:11], v[124:125], v[86:87] op_sel:[0,0,0] op_sel_hi:[1,0,1]
    v_pk_fma_f32 v[80:81], v[32:33], v[122:123], v[80:81] op_sel:[0,0,0] op_sel_hi:[1,0,1]
    v_pk_fma_f32 v[82:83], v[34:35], v[122:123], v[82:83] op_sel:[0,0,0] op_sel_hi:[1,0,1]
    v_pk_fma_f32 v[84:85], v[36:37], v[122:123], v[84:85] op_sel:[0,0,0] op_sel_hi:[1,0,1]
    v_pk_fma_f32 v[86:87], v[38:39], v[122:123], v[86:87] op_sel:[0,0,0] op_sel_hi:[1,0,1]
    v_max_f32 v80, 0, v80
    v_max_f32 v81, 0, v81
    v_max_f32 v82, 0, v82
    v_max_f32 v83, 0, v83
    v_max_f32 v84, 0, v84
    v_max_f32 v85, 0, v85
    v_max_f32 v86, 0, v86
    v_max_f32 v87, 0, v87
    v_pk_mul_f32 v[80:81], v[80:81], v[80:81]
    v_pk_mul_f32 v[82:83], v[82:83], v[82:83]
    v_pk_mul_f32 v[84:85], v[84:85], v[84:85]
    v_pk_mul_f32 v[86:87], v[86:87], v[86:87]
    v_cvt_pk_bf16_f32 v72, v80, v81
    v_cvt_pk_bf16_f32 v73, v82, v83
    v_cvt_pk_bf16_f32 v74, v84, v85
    v_cvt_pk_bf16_f32 v75, v86, v87
    s_nop 0
    v_permlane32_swap_b32 v72, v74
    v_permlane32_swap_b32 v73, v75
    s_add_u32 s90, s88, 2048
    buffer_store_dwordx4 v[72:75], v113, s[20:23], s90 offen sc1
    ds_read_b128 v[88:91], v112 offset:1280
    ds_read_b128 v[80:83], v112 offset:256
    ds_read_b128 v[4:7], v112 offset:2048
    ds_read_b128 v[92:95], v112 offset:1312
    ds_read_b128 v[84:87], v112 offset:288
    ds_read_b128 v[8:11], v112 offset:2080
    s_waitcnt lgkmcnt(10)
    v_pk_fma_f32 v[96:97], v[104:105], v[124:125], v[96:97] op_sel:[0,0,0] op_sel_hi:[1,0,1]
    v_pk_fma_f32 v[98:99], v[106:107], v[124:125], v[98:99] op_sel:[0,0,0] op_sel_hi:[1,0,1]
    s_waitcnt lgkmcnt(7)
    v_pk_fma_f32 v[100:101], v[108:109], v[124:125], v[100:101] op_sel:[0,0,0] op_sel_hi:[1,0,1]
    v_pk_fma_f32 v[102:103], v[110:111], v[124:125], v[102:103] op_sel:[0,0,0] op_sel_hi:[1,0,1]
    v_pk_fma_f32 v[96:97], v[12:13], v[124:125], v[96:97] op_sel:[0,0,0] op_sel_hi:[1,0,1]
    v_pk_fma_f32 v[98:99], v[14:15], v[124:125], v[98:99] op_sel:[0,0,0] op_sel_hi:[1,0,1]
    s_waitcnt lgkmcnt(6)
    v_pk_fma_f32 v[100:101], v[116:117], v[124:125], v[100:101] op_sel:[0,0,0] op_sel_hi:[1,0,1]
    v_pk_fma_f32 v[102:103], v[118:119], v[124:125], v[102:103] op_sel:[0,0,0] op_sel_hi:[1,0,1]
    v_pk_fma_f32 v[96:97], v[40:41], v[122:123], v[96:97] op_sel:[0,0,0] op_sel_hi:[1,0,1]
    v_pk_fma_f32 v[98:99], v[42:43], v[122:123], v[98:99] op_sel:[0,0,0] op_sel_hi:[1,0,1]
    v_pk_fma_f32 v[100:101], v[44:45], v[122:123], v[100:101] op_sel:[0,0,0] op_sel_hi:[1,0,1]
    v_pk_fma_f32 v[102:103], v[46:47], v[122:123], v[102:103] op_sel:[0,0,0] op_sel_hi:[1,0,1]
    v_max_f32 v96, 0, v96
    v_max_f32 v97, 0, v97
    v_max_f32 v98, 0, v98
    v_max_f32 v99, 0, v99
    v_max_f32 v100, 0, v100
    v_max_f32 v101, 0, v101
    v_max_f32 v102, 0, v102
    v_max_f32 v103, 0, v103
    v_pk_mul_f32 v[96:97], v[96:97], v[96:97]
    v_pk_mul_f32 v[98:99], v[98:99], v[98:99]
    v_pk_mul_f32 v[100:101], v[100:101], v[100:101]
    v_pk_mul_f32 v[102:103], v[102:103], v[102:103]
    v_cvt_pk_bf16_f32 v76, v96, v97
    v_cvt_pk_bf16_f32 v77, v98, v99
    v_cvt_pk_bf16_f32 v78, v100, v101
    v_cvt_pk_bf16_f32 v79, v102, v103
    s_nop 0
    v_permlane32_swap_b32 v76, v78
    v_permlane32_swap_b32 v77, v79
    s_add_u32 s90, s88, 3072
    buffer_store_dwordx4 v[76:79], v113, s[20:23], s90 offen sc1
    ds_read_b128 v[104:107], v112 offset:1344
    ds_read_b128 v[96:99], v112 offset:320
    ds_read_b128 v[12:15], v112 offset:2112
    ds_read_b128 v[108:111], v112 offset:1376
    ds_read_b128 v[100:103], v112 offset:352
    ds_read_b128 v[116:119], v112 offset:2144
    s_waitcnt lgkmcnt(10)
    v_pk_fma_f32 v[80:81], v[88:89], v[124:125], v[80:81] op_sel:[0,0,0] op_sel_hi:[1,0,1]
    v_pk_fma_f32 v[82:83], v[90:91], v[124:125], v[82:83] op_sel:[0,0,0] op_sel_hi:[1,0,1]
    s_waitcnt lgkmcnt(7)
    v_pk_fma_f32 v[84:85], v[92:93], v[124:125], v[84:85] op_sel:[0,0,0] op_sel_hi:[1,0,1]
    v_pk_fma_f32 v[86:87], v[94:95], v[124:125], v[86:87] op_sel:[0,0,0] op_sel_hi:[1,0,1]
    v_pk_fma_f32 v[80:81], v[4:5], v[124:125], v[80:81] op_sel:[0,0,0] op_sel_hi:[1,0,1]
    v_pk_fma_f32 v[82:83], v[6:7], v[124:125], v[82:83] op_sel:[0,0,0] op_sel_hi:[1,0,1]
    s_waitcnt lgkmcnt(6)
    v_pk_fma_f32 v[84:85], v[8:9], v[124:125], v[84:85] op_sel:[0,0,0] op_sel_hi:[1,0,1]
    v_pk_fma_f32 v[86:87], v[10:11], v[124:125], v[86:87] op_sel:[0,0,0] op_sel_hi:[1,0,1]
    v_pk_fma_f32 v[80:81], v[48:49], v[122:123], v[80:81] op_sel:[0,0,0] op_sel_hi:[1,0,1]
    v_pk_fma_f32 v[82:83], v[50:51], v[122:123], v[82:83] op_sel:[0,0,0] op_sel_hi:[1,0,1]
    v_pk_fma_f32 v[84:85], v[52:53], v[122:123], v[84:85] op_sel:[0,0,0] op_sel_hi:[1,0,1]
    v_pk_fma_f32 v[86:87], v[54:55], v[122:123], v[86:87] op_sel:[0,0,0] op_sel_hi:[1,0,1]
    v_max_f32 v80, 0, v80
    v_max_f32 v81, 0, v81
    v_max_f32 v82, 0, v82
    v_max_f32 v83, 0, v83
    v_max_f32 v84, 0, v84
    v_max_f32 v85, 0, v85
    v_max_f32 v86, 0, v86
    v_max_f32 v87, 0, v87
    v_pk_mul_f32 v[80:81], v[80:81], v[80:81]
    v_pk_mul_f32 v[82:83], v[82:83], v[82:83]
    v_pk_mul_f32 v[84:85], v[84:85], v[84:85]
    v_pk_mul_f32 v[86:87], v[86:87], v[86:87]
    v_cvt_pk_bf16_f32 v64, v80, v81
    v_cvt_pk_bf16_f32 v65, v82, v83
    v_cvt_pk_bf16_f32 v66, v84, v85
    v_cvt_pk_bf16_f32 v67, v86, v87
    s_nop 0
    v_permlane32_swap_b32 v64, v66
    v_permlane32_swap_b32 v65, v67
    s_mul_i32 s89, s74, 3
    s_add_u32 s89, s89, 2
    s_cmp_ge_u32 s89, s78
    s_cbranch_scc1 L_hs_21
    s_add_u32 s90, s88, 4096
    buffer_store_dwordx4 v[64:67], v113, s[20:23], s90 offen sc1
L_hs_21:
    s_waitcnt lgkmcnt(4)
    v_pk_fma_f32 v[96:97], v[104:105], v[124:125], v[96:97] op_sel:[0,0,0] op_sel_hi:[1,0,1]
    v_pk_fma_f32 v[98:99], v[106:107], v[124:125], v[98:99] op_sel:[0,0,0] op_sel_hi:[1,0,1]
    s_waitcnt lgkmcnt(1)
    v_pk_fma_f32 v[100:101], v[108:109], v[124:125], v[100:101] op_sel:[0,0,0] op_sel_hi:[1,0,1]
    v_pk_fma_f32 v[102:103], v[110:111], v[124:125], v[102:103] op_sel:[0,0,0] op_sel_hi:[1,0,1]
    v_pk_fma_f32 v[96:97], v[12:13], v[124:125], v[96:97] op_sel:[0,0,0] op_sel_hi:[1,0,1]
    v_pk_fma_f32 v[98:99], v[14:15], v[124:125], v[98:99] op_sel:[0,0,0] op_sel_hi:[1,0,1]
    s_waitcnt lgkmcnt(0)
    v_pk_fma_f32 v[100:101], v[116:117], v[124:125], v[100:101] op_sel:[0,0,0] op_sel_hi:[1,0,1]
    v_pk_fma_f32 v[102:103], v[118:119], v[124:125], v[102:103] op_sel:[0,0,0] op_sel_hi:[1,0,1]
    v_pk_fma_f32 v[96:97], v[56:57], v[122:123], v[96:97] op_sel:[0,0,0] op_sel_hi:[1,0,1]
    v_pk_fma_f32 v[98:99], v[58:59], v[122:123], v[98:99] op_sel:[0,0,0] op_sel_hi:[1,0,1]
    v_pk_fma_f32 v[100:101], v[60:61], v[122:123], v[100:101] op_sel:[0,0,0] op_sel_hi:[1,0,1]
    v_pk_fma_f32 v[102:103], v[62:63], v[122:123], v[102:103] op_sel:[0,0,0] op_sel_hi:[1,0,1]
    v_max_f32 v96, 0, v96
    v_max_f32 v97, 0, v97
    v_max_f32 v98, 0, v98
    v_max_f32 v99, 0, v99
    v_max_f32 v100, 0, v100
    v_max_f32 v101, 0, v101
    v_max_f32 v102, 0, v102
    v_max_f32 v103, 0, v103
    v_pk_mul_f32 v[96:97], v[96:97], v[96:97]
    v_pk_mul_f32 v[98:99], v[98:99], v[98:99]
    v_pk_mul_f32 v[100:101], v[100:101], v[100:101]
    v_pk_mul_f32 v[102:103], v[102:103], v[102:103]
    v_cvt_pk_bf16_f32 v68, v96, v97
    v_cvt_pk_bf16_f32 v69, v98, v99
    v_cvt_pk_bf16_f32 v70, v100, v101
    v_cvt_pk_bf16_f32 v71, v102, v103
    s_nop 0
    v_permlane32_swap_b32 v68, v70
    v_permlane32_swap_b32 v69, v71
    s_mul_i32 s89, s74, 3
    s_add_u32 s89, s89, 2
    s_cmp_ge_u32 s89, s78
    s_cbranch_scc1 L_hs_22
    s_add_u32 s90, s88, 5120
    buffer_store_dwordx4 v[68:71], v113, s[20:23], s90 offen sc1
L_hs_22:
    s_barrier
    ds_read_b64 a[32:33], v115 offset:0
    ds_read_b64 a[34:35], v115 offset:8
    ds_read_b128 a[0:3], v114 offset:3584
    ds_read_b64 a[36:37], v115 offset:512
    ds_read_b64 a[38:39], v115 offset:520
    ds_read_b128 a[4:7], v114 offset:3072
    ds_read_b64 a[40:41], v115 offset:1024
    ds_read_b64 a[42:43], v115 offset:1032
    ds_read_b128 a[8:11], v114 offset:2560
    ds_read_b64 a[44:45], v115 offset:1536
    ds_read_b64 a[46:47], v115 offset:1544
    ds_read_b128 a[12:15], v114 offset:2048
    ds_read_b64 a[48:49], v115 offset:2048
    ds_read_b64 a[50:51], v115 offset:2056
    ds_read_b128 a[16:19], v114 offset:1536
    ds_read_b64 a[52:53], v115 offset:2560
    ds_read_b64 a[54:55], v115 offset:2568
    ds_read_b128 a[20:23], v114 offset:1024
    ds_read_b64 a[56:57], v115 offset:3072
    ds_read_b64 a[58:59], v115 offset:3080
    ds_read_b128 a[24:27], v114 offset:512
    ds_read_b64 a[60:61], v115 offset:3584
    ds_read_b64 a[62:63], v115 offset:3592
    ds_read_b128 a[28:31], v114 offset:0
    s_waitcnt lgkmcnt(15)
    v_mfma_f32_16x16x32_bf16 v[16:19], a[32:35], a[0:3], 0
    v_mfma_f32_16x16x32_bf16 v[20:23], a[32:35], a[4:7], 0
    v_mfma_f32_16x16x32_bf16 v[20:23], a[36:39], a[0:3], v[20:23]
    v_mfma_f32_16x16x32_bf16 v[24:27], a[36:39], a[4:7], 0
    v_mfma_f32_16x16x32_bf16 v[24:27], a[32:35], a[8:11], v[24:27]
    ds_read_b64 a[96:97], v115 offset:64
    v_mfma_f32_16x16x32_bf16 v[24:27], a[40:43], a[0:3], v[24:27]
    ds_read_b64 a[98:99], v115 offset:72
    v_mfma_f32_16x16x32_bf16 v[28:31], a[36:39], a[8:11], 0
    ds_read_b128 a[64:67], v114 offset:3648
    v_mfma_f32_16x16x32_bf16 v[28:31], a[40:43], a[4:7], v[28:31]
    ds_read_b64 a[100:101], v115 offset:576
    v_mfma_f32_16x16x32_bf16 v[32:35], a[40:43], a[8:11], 0
    ds_read_b64 a[102:103], v115 offset:584
    s_waitcnt lgkmcnt(15)
    v_mfma_f32_16x16x32_bf16 v[28:31], a[32:35], a[12:15], v[28:31]
    ds_read_b128 a[68:71], v114 offset:3136
    v_mfma_f32_16x16x32_bf16 v[28:31], a[44:47], a[0:3], v[28:31]
    ds_read_b64 a[104:105], v115 offset:1088
    v_mfma_f32_16x16x32_bf16 v[32:35], a[36:39], a[12:15], v[32:35]
    ds_read_b64 a[106:107], v115 offset:1096
    v_mfma_f32_16x16x32_bf16 v[32:35], a[44:47], a[4:7], v[32:35]
    ds_read_b128 a[72:75], v114 offset:2624
    v_mfma_f32_16x16x32_bf16 v[36:39], a[40:43], a[12:15], 0
    ds_read_b64 a[108:109], v115 offset:1600
    v_mfma_f32_16x16x32_bf16 v[36:39], a[44:47], a[8:11], v[36:39]
    ds_read_b64 a[110:111], v115 offset:1608
    v_mfma_f32_16x16x32_bf16 v[40:43], a[44:47], a[12:15], 0
    ds_read_b128 a[76:79], v114 offset:2112
    s_waitcnt lgkmcnt(15)
    v_mfma_f32_16x16x32_bf16 v[32:35], a[32:35], a[16:19], v[32:35]
    ds_read_b64 a[112:113], v115 offset:2112
    v_mfma_f32_16x16x32_bf16 v[32:35], a[48:51], a[0:3], v[32:35]
    ds_read_b64 a[114:115], v115 offset:2120
    v_mfma_f32_16x16x32_bf16 v[36:39], a[36:39], a[16:19], v[36:39]
    ds_read_b128 a[80:83], v114 offset:1600
    v_mfma_f32_16x16x32_bf16 v[36:39], a[48:51], a[4:7], v[36:39]
    ds_read_b64 a[116:117], v115 offset:2624
    v_mfma_f32_16x16x32_bf16 v[40:43], a[40:43], a[16:19], v[40:43]
    s_waitcnt vmcnt(0)
    s_lshl_b32 s80, s71, 7
    s_lshl_b32 s81, s72, 4
    s_add_u32 s80, s80, s81
    s_lshl_b32 s81, s70, 2
    s_add_u32 s80, s80, s81
    s_add_u32 s80, s80, 4096
    v_mov_b32 v8, s75
    v_mov_b32 v9, s80
    s_mov_b64 exec, 1
    buffer_store_dword v8, v9, s[20:23], 0 offen sc1
    s_mov_b64 exec, -1
    s_nop 1
    ds_read_b64 a[118:119], v115 offset:2632
    v_mfma_f32_16x16x32_bf16 v[40:43], a[48:51], a[8:11], v[40:43]
    ds_read_b128 a[84:87], v114 offset:1088
    v_mfma_f32_16x16x32_bf16 v[44:47], a[44:47], a[16:19], 0
    ds_read_b64 a[120:121], v115 offset:3136
    v_mfma_f32_16x16x32_bf16 v[44:47], a[48:51], a[12:15], v[44:47]
    ds_read_b64 a[122:123], v115 offset:3144
    v_mfma_f32_16x16x32_bf16 v[36:39], a[32:35], a[20:23], v[36:39]
    ds_read_b128 a[88:91], v114 offset:576
    v_mfma_f32_16x16x32_bf16 v[36:39], a[52:55], a[0:3], v[36:39]
    ds_read_b64 a[124:125], v115 offset:3648
    v_mfma_f32_16x16x32_bf16 v[40:43], a[36:39], a[20:23], v[40:43]
    ds_read_b64 a[126:127], v115 offset:3656
    v_mfma_f32_16x16x32_bf16 v[40:43], a[52:55], a[4:7], v[40:43]
    ds_read_b128 a[92:95], v114 offset:64
    v_mfma_f32_16x16x32_bf16 v[44:47], a[40:43], a[20:23], v[44:47]
    v_mfma_f32_16x16x32_bf16 v[44:47], a[52:55], a[8:11], v[44:47]
    v_mfma_f32_16x16x32_bf16 v[40:43], a[32:35], a[24:27], v[40:43]
    v_mfma_f32_16x16x32_bf16 v[40:43], a[56:59], a[0:3], v[40:43]
    v_mfma_f32_16x16x32_bf16 v[44:47], a[36:39], a[24:27], v[44:47]
    v_mfma_f32_16x16x32_bf16 v[44:47], a[56:59], a[4:7], v[44:47]
    s_waitcnt lgkmcnt(15)
    v_mfma_f32_16x16x32_bf16 v[44:47], a[32:35], a[28:31], v[44:47]
    v_mfma_f32_16x16x32_bf16 v[44:47], a[60:63], a[0:3], v[44:47]
    v_mfma_f32_16x16x32_bf16 v[16:19], a[96:99], a[64:67], v[16:19]
    v_mfma_f32_16x16x32_bf16 v[20:23], a[96:99], a[68:71], v[20:23]
    v_mfma_f32_16x16x32_bf16 v[20:23], a[100:103], a[64:67], v[20:23]
    v_mfma_f32_16x16x32_bf16 v[24:27], a[100:103], a[68:71], v[24:27]
    v_mfma_f32_16x16x32_bf16 v[24:27], a[96:99], a[72:75], v[24:27]
    ds_read_b64 a[32:33], v115 offset:128
    v_mfma_f32_16x16x32_bf16 v[24:27], a[104:107], a[64:67], v[24:27]
    ds_read_b64 a[34:35], v115 offset:136
    v_mfma_f32_16x16x32_bf16 v[28:31], a[100:103], a[72:75], v[28:31]
    ds_read_b128 a[0:3], v114 offset:3712
    v_mfma_f32_16x16x32_bf16 v[28:31], a[104:107], a[68:71], v[28:31]
    ds_read_b64 a[36:37], v115 offset:640
    v_mfma_f32_16x16x32_bf16 v[32:35], a[104:107], a[72:75], v[32:35]
    ds_read_b64 a[38:39], v115 offset:648
    s_waitcnt lgkmcnt(15)
    v_mfma_f32_16x16x32_bf16 v[28:31], a[96:99], a[76:79], v[28:31]
    ds_read_b128 a[4:7], v114 offset:3200
    v_mfma_f32_16x16x32_bf16 v[28:31], a[108:111], a[64:67], v[28:31]
    ds_read_b64 a[40:41], v115 offset:1152
    v_mfma_f32_16x16x32_bf16 v[32:35], a[100:103], a[76:79], v[32:35]
    ds_read_b64 a[42:43], v115 offset:1160
    v_mfma_f32_16x16x32_bf16 v[32:35], a[108:111], a[68:71], v[32:35]
    ds_read_b128 a[8:11], v114 offset:2688
    v_mfma_f32_16x16x32_bf16 v[36:39], a[104:107], a[76:79], v[36:39]
    ds_read_b64 a[44:45], v115 offset:1664
    v_mfma_f32_16x16x32_bf16 v[36:39], a[108:111], a[72:75], v[36:39]
    ds_read_b64 a[46:47], v115 offset:1672
    v_mfma_f32_16x16x32_bf16 v[40:43], a[108:111], a[76:79], v[40:43]
    ds_read_b128 a[12:15], v114 offset:2176
    s_waitcnt lgkmcnt(15)
    v_mfma_f32_16x16x32_bf16 v[32:35], a[96:99], a[80:83], v[32:35]
    ds_read_b64 a[48:49], v115 offset:2176
    v_mfma_f32_16x16x32_bf16 v[32:35], a[112:115], a[64:67], v[32:35]
    ds_read_b64 a[50:51], v115 offset:2184
    v_mfma_f32_16x16x32_bf16 v[36:39], a[100:103], a[80:83], v[36:39]
    ds_read_b128 a[16:19], v114 offset:1664
    v_mfma_f32_16x16x32_bf16 v[36:39], a[112:115], a[68:71], v[36:39]
    ds_read_b64 a[52:53], v115 offset:2688
    v_mfma_f32_16x16x32_bf16 v[40:43], a[104:107], a[80:83], v[40:43]
    ds_read_b64 a[54:55], v115 offset:2696
    v_mfma_f32_16x16x32_bf16 v[40:43], a[112:115], a[72:75], v[40:43]
    ds_read_b128 a[20:23], v114 offset:1152
    v_mfma_f32_16x16x32_bf16 v[44:47], a[108:111], a[80:83], v[44:47]
    ds_read_b64 a[56:57], v115 offset:3200
    v_mfma_f32_16x16x32_bf16 v[44:47], a[112:115], a[76:79], v[44:47]
    ds_read_b64 a[58:59], v115 offset:3208
    v_mfma_f32_16x16x32_bf16 v[36:39], a[96:99], a[84:87], v[36:39]
    ds_read_b128 a[24:27], v114 offset:640
    v_mfma_f32_16x16x32_bf16 v[36:39], a[116:119], a[64:67], v[36:39]
    ds_read_b64 a[60:61], v115 offset:3712
    v_mfma_f32_16x16x32_bf16 v[40:43], a[100:103], a[84:87], v[40:43]
    ds_read_b64 a[62:63], v115 offset:3720
    v_mfma_f32_16x16x32_bf16 v[40:43], a[116:119], a[68:71], v[40:43]
    ds_read_b128 a[28:31], v114 offset:128
    v_mfma_f32_16x16x32_bf16 v[44:47], a[104:107], a[84:87], v[44:47]
    v_mfma_f32_16x16x32_bf16 v[44:47], a[116:119], a[72:75], v[44:47]
    v_mfma_f32_16x16x32_bf16 v[40:43], a[96:99], a[88:91], v[40:43]
    v_mfma_f32_16x16x32_bf16 v[40:43], a[120:123], a[64:67], v[40:43]
    v_mfma_f32_16x16x32_bf16 v[44:47], a[100:103], a[88:91], v[44:47]
    v_mfma_f32_16x16x32_bf16 v[44:47], a[120:123], a[68:71], v[44:47]
    s_waitcnt lgkmcnt(15)
    v_mfma_f32_16x16x32_bf16 v[44:47], a[96:99], a[92:95], v[44:47]
    v_mfma_f32_16x16x32_bf16 v[44:47], a[124:127], a[64:67], v[44:47]
    v_mfma_f32_16x16x32_bf16 v[16:19], a[32:35], a[0:3], v[16:19]
    v_mfma_f32_16x16x32_bf16 v[20:23], a[32:35], a[4:7], v[20:23]
    v_mfma_f32_16x16x32_bf16 v[20:23], a[36:39], a[0:3], v[20:23]
    v_mfma_f32_16x16x32_bf16 v[24:27], a[36:39], a[4:7], v[24:27]
    v_mfma_f32_16x16x32_bf16 v[24:27], a[32:35], a[8:11], v[24:27]
    ds_read_b64 a[96:97], v115 offset:192
    v_mfma_f32_16x16x32_bf16 v[24:27], a[40:43], a[0:3], v[24:27]
    ds_read_b64 a[98:99], v115 offset:200
    v_mfma_f32_16x16x32_bf16 v[28:31], a[36:39], a[8:11], v[28:31]
    ds_read_b128 a[64:67], v114 offset:3776
    v_mfma_f32_16x16x32_bf16 v[28:31], a[40:43], a[4:7], v[28:31]
    ds_read_b64 a[100:101], v115 offset:704
    v_mfma_f32_16x16x32_bf16 v[32:35], a[40:43], a[8:11], v[32:35]
    ds_read_b64 a[102:103], v115 offset:712
    s_waitcnt lgkmcnt(15)
    v_mfma_f32_16x16x32_bf16 v[28:31], a[32:35], a[12:15], v[28:31]
    ds_read_b128 a[68:71], v114 offset:3264
    v_mfma_f32_16x16x32_bf16 v[28:31], a[44:47], a[0:3], v[28:31]
    ds_read_b64 a[104:105], v115 offset:1216
    v_mfma_f32_16x16x32_bf16 v[32:35], a[36:39], a[12:15], v[32:35]
    ds_read_b64 a[106:107], v115 offset:1224
    v_mfma_f32_16x16x32_bf16 v[32:35], a[44:47], a[4:7], v[32:35]
    ds_read_b128 a[72:75], v114 offset:2752
    v_mfma_f32_16x16x32_bf16 v[36:39], a[40:43], a[12:15], v[36:39]
    ds_read_b64 a[108:109], v115 offset:1728
    v_mfma_f32_16x16x32_bf16 v[36:39], a[44:47], a[8:11], v[36:39]
    ds_read_b64 a[110:111], v115 offset:1736
    v_mfma_f32_16x16x32_bf16 v[40:43], a[44:47], a[12:15], v[40:43]
    ds_read_b128 a[76:79], v114 offset:2240
    s_waitcnt lgkmcnt(15)
    v_mfma_f32_16x16x32_bf16 v[32:35], a[32:35], a[16:19], v[32:35]
    ds_read_b64 a[112:113], v115 offset:2240
    v_mfma_f32_16x16x32_bf16 v[32:35], a[48:51], a[0:3], v[32:35]
    ds_read_b64 a[114:115], v115 offset:2248
    v_mfma_f32_16x16x32_bf16 v[36:39], a[36:39], a[16:19], v[36:39]
    ds_read_b128 a[80:83], v114 offset:1728
    v_mfma_f32_16x16x32_bf16 v[36:39], a[48:51], a[4:7], v[36:39]
    ds_read_b64 a[116:117], v115 offset:2752
    v_mfma_f32_16x16x32_bf16 v[40:43], a[40:43], a[16:19], v[40:43]
    ds_read_b64 a[118:119], v115 offset:2760
    v_mfma_f32_16x16x32_bf16 v[40:43], a[48:51], a[8:11], v[40:43]
    ds_read_b128 a[84:87], v114 offset:1216
    v_mfma_f32_16x16x32_bf16 v[44:47], a[44:47], a[16:19], v[44:47]
    ds_read_b64 a[120:121], v115 offset:3264
    v_mfma_f32_16x16x32_bf16 v[44:47], a[48:51], a[12:15], v[44:47]
    ds_read_b64 a[122:123], v115 offset:3272
    v_mfma_f32_16x16x32_bf16 v[36:39], a[32:35], a[20:23], v[36:39]
    ds_read_b128 a[88:91], v114 offset:704
    v_mfma_f32_16x16x32_bf16 v[36:39], a[52:55], a[0:3], v[36:39]
    ds_read_b64 a[124:125], v115 offset:3776
    v_mfma_f32_16x16x32_bf16 v[40:43], a[36:39], a[20:23], v[40:43]
    ds_read_b64 a[126:127], v115 offset:3784
    v_mfma_f32_16x16x32_bf16 v[40:43], a[52:55], a[4:7], v[40:43]
    ds_read_b128 a[92:95], v114 offset:192
    v_mfma_f32_16x16x32_bf16 v[44:47], a[40:43], a[20:23], v[44:47]
    v_mfma_f32_16x16x32_bf16 v[44:47], a[52:55], a[8:11], v[44:47]
    v_mfma_f32_16x16x32_bf16 v[40:43], a[32:35], a[24:27], v[40:43]
    v_mfma_f32_16x16x32_bf16 v[40:43], a[56:59], a[0:3], v[40:43]
    v_mfma_f32_16x16x32_bf16 v[44:47], a[36:39], a[24:27], v[44:47]
    v_mfma_f32_16x16x32_bf16 v[44:47], a[56:59], a[4:7], v[44:47]
    s_waitcnt lgkmcnt(15)
    v_mfma_f32_16x16x32_bf16 v[44:47], a[32:35], a[28:31], v[44:47]
    v_mfma_f32_16x16x32_bf16 v[44:47], a[60:63], a[0:3], v[44:47]
    v_mfma_f32_16x16x32_bf16 v[16:19], a[96:99], a[64:67], v[16:19]
    v_lshrrev_b32 v2, 5, v1
    v_lshrrev_b32 v3, 2, v1
    v_mfma_f32_16x16x32_bf16 v[20:23], a[96:99], a[68:71], v[20:23]
    v_and_b32 v3, 3, v3
    v_lshrrev_b32 v5, 1, v3
    v_mfma_f32_16x16x32_bf16 v[20:23], a[100:103], a[64:67], v[20:23]
    v_lshl_add_u32 v3, v2, 3, v3
    v_lshlrev_b32 v3, 7, v3
    v_mfma_f32_16x16x32_bf16 v[24:27], a[100:103], a[68:71], v[24:27]
    v_lshl_add_u32 v3, v5, 6, v3
    v_lshrrev_b32 v4, 4, v1
    v_mfma_f32_16x16x32_bf16 v[24:27], a[96:99], a[72:75], v[24:27]
    v_and_b32 v4, 1, v4
    v_lshl_add_u32 v3, v4, 5, v3
    v_mfma_f32_16x16x32_bf16 v[24:27], a[104:107], a[64:67], v[24:27]
    v_and_b32 v4, 3, v1
    v_lshl_add_u32 v3, v4, 3, v3
    v_mfma_f32_16x16x32_bf16 v[28:31], a[100:103], a[72:75], v[28:31]
    s_xor_b32 s81, s74, 1
    s_lshl_b32 s81, s81, 6
    v_mfma_f32_16x16x32_bf16 v[28:31], a[104:107], a[68:71], v[28:31]
    v_xor_b32 v3, s81, v3
    v_xor_b32 v4, 64, v3
    v_mfma_f32_16x16x32_bf16 v[32:35], a[104:107], a[72:75], v[32:35]
    s_lshl_b32 s80, s74, 11
    v_add_u32 v116, s80, v3
    s_waitcnt lgkmcnt(12)
    v_mfma_f32_16x16x32_bf16 v[28:31], a[96:99], a[76:79], v[28:31]
    v_add_u32 v112, s80, v4
    v_add_u32 v117, s80, v3
    v_mfma_f32_16x16x32_bf16 v[28:31], a[108:111], a[64:67], v[28:31]
    v_add_u32 v113, s80, v4
    v_add_u32 v117, 65536, v117
    v_mfma_f32_16x16x32_bf16 v[32:35], a[100:103], a[76:79], v[32:35]
    v_add_u32 v113, 65536, v113
    v_add_u32 v118, s80, v3
    v_mfma_f32_16x16x32_bf16 v[32:35], a[108:111], a[68:71], v[32:35]
    v_add_u32 v114, s80, v4
    v_add_u32 v118, 131072, v118
    v_mfma_f32_16x16x32_bf16 v[36:39], a[104:107], a[76:79], v[36:39]
    v_add_u32 v114, 131072, v114
    s_lshl_b32 s99, s71, 1
    v_mfma_f32_16x16x32_bf16 v[36:39], a[108:111], a[72:75], v[36:39]
    s_add_u32 s99, s99, s73
    s_mul_i32 s99, s99, 86
    v_mfma_f32_16x16x32_bf16 v[40:43], a[108:111], a[76:79], v[40:43]
    s_add_u32 s99, s99, s74
    s_lshl_b32 s99, s99, 10
    s_waitcnt lgkmcnt(9)
    v_mfma_f32_16x16x32_bf16 v[32:35], a[96:99], a[80:83], v[32:35]
    s_add_u32 s99, s99, 4194304
    v_lshlrev_b32 v119, 4, v1
    v_mfma_f32_16x16x32_bf16 v[32:35], a[112:115], a[64:67], v[32:35]
    v_mfma_f32_16x16x32_bf16 v[36:39], a[100:103], a[80:83], v[36:39]
    v_mfma_f32_16x16x32_bf16 v[36:39], a[112:115], a[68:71], v[36:39]
    v_mfma_f32_16x16x32_bf16 v[40:43], a[104:107], a[80:83], v[40:43]
    v_mfma_f32_16x16x32_bf16 v[40:43], a[112:115], a[72:75], v[40:43]
    v_mfma_f32_16x16x32_bf16 v[44:47], a[108:111], a[80:83], v[44:47]
    v_mfma_f32_16x16x32_bf16 v[44:47], a[112:115], a[76:79], v[44:47]
    s_waitcnt lgkmcnt(6)
    v_mfma_f32_16x16x32_bf16 v[36:39], a[96:99], a[84:87], v[36:39]
    v_mfma_f32_16x16x32_bf16 v[36:39], a[116:119], a[64:67], v[36:39]
    v_mfma_f32_16x16x32_bf16 v[40:43], a[100:103], a[84:87], v[40:43]
    v_mfma_f32_16x16x32_bf16 v[40:43], a[116:119], a[68:71], v[40:43]
    v_mfma_f32_16x16x32_bf16 v[44:47], a[104:107], a[84:87], v[44:47]
    v_mfma_f32_16x16x32_bf16 v[44:47], a[116:119], a[72:75], v[44:47]
    s_waitcnt lgkmcnt(3)
    v_mfma_f32_16x16x32_bf16 v[40:43], a[96:99], a[88:91], v[40:43]
    v_mfma_f32_16x16x32_bf16 v[40:43], a[120:123], a[64:67], v[40:43]
    v_mfma_f32_16x16x32_bf16 v[44:47], a[100:103], a[88:91], v[44:47]
    v_mfma_f32_16x16x32_bf16 v[44:47], a[120:123], a[68:71], v[44:47]
    s_waitcnt lgkmcnt(0)
    v_mfma_f32_16x16x32_bf16 v[44:47], a[96:99], a[92:95], v[44:47]
    v_mfma_f32_16x16x32_bf16 v[44:47], a[124:127], a[64:67], v[44:47]
    s_barrier
    s_add_u32 s94, s99, 0
    buffer_load_dwordx4 a[0:3], v119, s[20:23], s94 offen offset:0 sc1
    buffer_load_dwordx4 a[4:7], v119, s[20:23], s94 offen offset:2048 sc1
    s_add_u32 s94, s99, 4096
    buffer_load_dwordx4 a[8:11], v119, s[20:23], s94 offen offset:0 sc1
    buffer_load_dwordx4 a[12:15], v119, s[20:23], s94 offen offset:2048 sc1
    s_add_u32 s94, s99, 8192
    buffer_load_dwordx4 a[16:19], v119, s[20:23], s94 offen offset:0 sc1
    buffer_load_dwordx4 a[20:23], v119, s[20:23], s94 offen offset:2048 sc1
    s_add_u32 s94, s99, 12288
    buffer_load_dwordx4 a[24:27], v119, s[20:23], s94 offen offset:0 sc1
    buffer_load_dwordx4 a[28:31], v119, s[20:23], s94 offen offset:2048 sc1
    s_add_u32 s94, s99, 16384
    buffer_load_dwordx4 a[32:35], v119, s[20:23], s94 offen offset:0 sc1
    buffer_load_dwordx4 a[36:39], v119, s[20:23], s94 offen offset:2048 sc1
    s_add_u32 s94, s99, 20480
    buffer_load_dwordx4 a[40:43], v119, s[20:23], s94 offen offset:0 sc1
    buffer_load_dwordx4 a[44:47], v119, s[20:23], s94 offen offset:2048 sc1
    ds_read_b64_tr_b16 v[48:49], v116 offset:0
    ds_read_b64_tr_b16 v[50:51], v116 offset:512
    ds_read_b64_tr_b16 v[52:53], v112 offset:0
    ds_read_b64_tr_b16 v[54:55], v112 offset:512
    ds_read_b64_tr_b16 v[56:57], v116 offset:4096
    ds_read_b64_tr_b16 v[58:59], v116 offset:4608
    ds_read_b64_tr_b16 v[60:61], v112 offset:4096
    ds_read_b64_tr_b16 v[62:63], v112 offset:4608
    s_lshl_b32 s80, s70, 13
    s_add_u32 s80, s80, 114688
    v_lshlrev_b32 v12, 4, v1
    v_add_u32 v12, s80, v12
    ds_write_b128 v12, v[16:19] offset:0
    ds_write_b128 v12, v[20:23] offset:1024
    ds_write_b128 v12, v[24:27] offset:2048
    ds_write_b128 v12, v[28:31] offset:3072
    ds_write_b128 v12, v[32:35] offset:4096
    ds_write_b128 v12, v[36:39] offset:5120
    ds_write_b128 v12, v[40:43] offset:6144
    ds_write_b128 v12, v[44:47] offset:7168
    s_waitcnt lgkmcnt(0)
    s_barrier
    s_waitcnt vmcnt(11)
    v_mfma_f32_32x32x16_bf16 v[16:31], v[48:51], a[0:3], 0
    ds_read_b64_tr_b16 v[64:65], v116 offset:8192
    ds_read_b64_tr_b16 v[66:67], v116 offset:8704
    v_mfma_f32_32x32x16_bf16 v[32:47], v[52:55], a[0:3], 0
    ds_read_b64_tr_b16 v[68:69], v112 offset:8192
    ds_read_b64_tr_b16 v[70:71], v112 offset:8704
    s_add_u32 s94, s99, 24576
    buffer_load_dwordx4 a[48:51], v119, s[20:23], s94 offen offset:0 sc1
    s_waitcnt vmcnt(11)
    v_mfma_f32_32x32x16_bf16 v[16:31], v[56:59], a[4:7], v[16:31]
    ds_read_b64_tr_b16 v[72:73], v116 offset:12288
    ds_read_b64_tr_b16 v[74:75], v116 offset:12800
    v_mfma_f32_32x32x16_bf16 v[32:47], v[60:63], a[4:7], v[32:47]
    ds_read_b64_tr_b16 v[76:77], v112 offset:12288
    ds_read_b64_tr_b16 v[78:79], v112 offset:12800
    buffer_load_dwordx4 a[52:55], v119, s[20:23], s94 offen offset:2048 sc1
    s_waitcnt vmcnt(11) lgkmcnt(6)
    v_mfma_f32_32x32x16_bf16 v[16:31], v[64:67], a[8:11], v[16:31]
    ds_read_b64_tr_b16 v[48:49], v116 offset:16384
    ds_read_b64_tr_b16 v[50:51], v116 offset:16896
    s_waitcnt lgkmcnt(6)
    v_mfma_f32_32x32x16_bf16 v[32:47], v[68:71], a[8:11], v[32:47]
    ds_read_b64_tr_b16 v[52:53], v112 offset:16384
    ds_read_b64_tr_b16 v[54:55], v112 offset:16896
    s_add_u32 s94, s99, 28672
    buffer_load_dwordx4 a[56:59], v119, s[20:23], s94 offen offset:0 sc1
    s_waitcnt vmcnt(11) lgkmcnt(6)
    v_mfma_f32_32x32x16_bf16 v[16:31], v[72:75], a[12:15], v[16:31]
    ds_read_b64_tr_b16 v[56:57], v116 offset:20480
    ds_read_b64_tr_b16 v[58:59], v116 offset:20992
    s_waitcnt lgkmcnt(6)
    v_mfma_f32_32x32x16_bf16 v[32:47], v[76:79], a[12:15], v[32:47]
    ds_read_b64_tr_b16 v[60:61], v112 offset:20480
    ds_read_b64_tr_b16 v[62:63], v112 offset:20992
    buffer_load_dwordx4 a[60:63], v119, s[20:23], s94 offen offset:2048 sc1
    s_waitcnt vmcnt(11) lgkmcnt(6)
    v_mfma_f32_32x32x16_bf16 v[16:31], v[48:51], a[16:19], v[16:31]
    ds_read_b64_tr_b16 v[64:65], v116 offset:24576
    ds_read_b64_tr_b16 v[66:67], v116 offset:25088
    s_waitcnt lgkmcnt(6)
    v_mfma_f32_32x32x16_bf16 v[32:47], v[52:55], a[16:19], v[32:47]
    ds_read_b64_tr_b16 v[68:69], v112 offset:24576
    ds_read_b64_tr_b16 v[70:71], v112 offset:25088
    s_add_u32 s94, s99, 32768
    buffer_load_dwordx4 a[64:67], v119, s[20:23], s94 offen offset:0 sc1
    s_waitcnt vmcnt(11) lgkmcnt(6)
    v_mfma_f32_32x32x16_bf16 v[16:31], v[56:59], a[20:23], v[16:31]
    ds_read_b64_tr_b16 v[72:73], v116 offset:28672
    ds_read_b64_tr_b16 v[74:75], v116 offset:29184
    s_waitcnt lgkmcnt(6)
    v_mfma_f32_32x32x16_bf16 v[32:47], v[60:63], a[20:23], v[32:47]
    ds_read_b64_tr_b16 v[76:77], v112 offset:28672
    ds_read_b64_tr_b16 v[78:79], v112 offset:29184
    buffer_load_dwordx4 a[68:71], v119, s[20:23], s94 offen offset:2048 sc1
    s_barrier
    s_waitcnt vmcnt(11) lgkmcnt(6)
    v_mfma_f32_32x32x16_bf16 v[16:31], v[64:67], a[24:27], v[16:31]
    ds_read_b64_tr_b16 v[48:49], v116 offset:32768
    ds_read_b64_tr_b16 v[50:51], v116 offset:33280
    s_waitcnt lgkmcnt(6)
    v_mfma_f32_32x32x16_bf16 v[32:47], v[68:71], a[24:27], v[32:47]
    ds_read_b64_tr_b16 v[52:53], v112 offset:32768
    ds_read_b64_tr_b16 v[54:55], v112 offset:33280
    s_add_u32 s94, s99, 36864
    buffer_load_dwordx4 a[72:75], v119, s[20:23], s94 offen offset:0 sc1
    s_waitcnt vmcnt(11) lgkmcnt(6)
    v_mfma_f32_32x32x16_bf16 v[16:31], v[72:75], a[28:31], v[16:31]
    ds_read_b64_tr_b16 v[56:57], v116 offset:36864
    ds_read_b64_tr_b16 v[58:59], v116 offset:37376
    s_waitcnt lgkmcnt(6)
    v_mfma_f32_32x32x16_bf16 v[32:47], v[76:79], a[28:31], v[32:47]
    ds_read_b64_tr_b16 v[60:61], v112 offset:36864
    ds_read_b64_tr_b16 v[62:63], v112 offset:37376
    buffer_load_dwordx4 a[76:79], v119, s[20:23], s94 offen offset:2048 sc1
    s_waitcnt vmcnt(11) lgkmcnt(6)
    v_mfma_f32_32x32x16_bf16 v[16:31], v[48:51], a[32:35], v[16:31]
    ds_read_b64_tr_b16 v[64:65], v116 offset:40960
    ds_read_b64_tr_b16 v[66:67], v116 offset:41472
    s_waitcnt lgkmcnt(6)
    v_mfma_f32_32x32x16_bf16 v[32:47], v[52:55], a[32:35], v[32:47]
    ds_read_b64_tr_b16 v[68:69], v112 offset:40960
    ds_read_b64_tr_b16 v[70:71], v112 offset:41472
    s_add_u32 s94, s99, 40960
    buffer_load_dwordx4 a[80:83], v119, s[20:23], s94 offen offset:0 sc1
    s_waitcnt vmcnt(11) lgkmcnt(6)
    v_mfma_f32_32x32x16_bf16 v[16:31], v[56:59], a[36:39], v[16:31]
    ds_read_b64_tr_b16 v[72:73], v116 offset:45056
    ds_read_b64_tr_b16 v[74:75], v116 offset:45568
    s_waitcnt lgkmcnt(6)
    v_mfma_f32_32x32x16_bf16 v[32:47], v[60:63], a[36:39], v[32:47]
    ds_read_b64_tr_b16 v[76:77], v112 offset:45056
    ds_read_b64_tr_b16 v[78:79], v112 offset:45568
    buffer_load_dwordx4 a[84:87], v119, s[20:23], s94 offen offset:2048 sc1
    s_waitcnt vmcnt(11) lgkmcnt(6)
    v_mfma_f32_32x32x16_bf16 v[16:31], v[64:67], a[40:43], v[16:31]
    ds_read_b64_tr_b16 v[48:49], v116 offset:49152
    ds_read_b64_tr_b16 v[50:51], v116 offset:49664
    s_waitcnt lgkmcnt(6)
    v_mfma_f32_32x32x16_bf16 v[32:47], v[68:71], a[40:43], v[32:47]
    ds_read_b64_tr_b16 v[52:53], v112 offset:49152
    ds_read_b64_tr_b16 v[54:55], v112 offset:49664
    s_add_u32 s94, s99, 45056
    buffer_load_dwordx4 a[88:91], v119, s[20:23], s94 offen offset:0 sc1
    s_waitcnt vmcnt(11) lgkmcnt(6)
    v_mfma_f32_32x32x16_bf16 v[16:31], v[72:75], a[44:47], v[16:31]
    ds_read_b64_tr_b16 v[56:57], v116 offset:53248
    ds_read_b64_tr_b16 v[58:59], v116 offset:53760
    s_waitcnt lgkmcnt(6)
    v_mfma_f32_32x32x16_bf16 v[32:47], v[76:79], a[44:47], v[32:47]
    ds_read_b64_tr_b16 v[60:61], v112 offset:53248
    ds_read_b64_tr_b16 v[62:63], v112 offset:53760
    buffer_load_dwordx4 a[92:95], v119, s[20:23], s94 offen offset:2048 sc1
    s_waitcnt vmcnt(11) lgkmcnt(6)
    v_mfma_f32_32x32x16_bf16 v[16:31], v[48:51], a[48:51], v[16:31]
    ds_read_b64_tr_b16 v[64:65], v116 offset:57344
    ds_read_b64_tr_b16 v[66:67], v116 offset:57856
    s_waitcnt lgkmcnt(6)
    v_mfma_f32_32x32x16_bf16 v[32:47], v[52:55], a[48:51], v[32:47]
    ds_read_b64_tr_b16 v[68:69], v112 offset:57344
    ds_read_b64_tr_b16 v[70:71], v112 offset:57856
    s_add_u32 s94, s99, 49152
    buffer_load_dwordx4 a[0:3], v119, s[20:23], s94 offen offset:0 sc1
    s_waitcnt vmcnt(11) lgkmcnt(6)
    v_mfma_f32_32x32x16_bf16 v[16:31], v[56:59], a[52:55], v[16:31]
    ds_read_b64_tr_b16 v[72:73], v116 offset:61440
    ds_read_b64_tr_b16 v[74:75], v116 offset:61952
    s_waitcnt lgkmcnt(6)
    v_mfma_f32_32x32x16_bf16 v[32:47], v[60:63], a[52:55], v[32:47]
    ds_read_b64_tr_b16 v[76:77], v112 offset:61440
    ds_read_b64_tr_b16 v[78:79], v112 offset:61952
    buffer_load_dwordx4 a[4:7], v119, s[20:23], s94 offen offset:2048 sc1
    s_waitcnt vmcnt(11) lgkmcnt(6)
    v_mfma_f32_32x32x16_bf16 v[16:31], v[64:67], a[56:59], v[16:31]
    ds_read_b64_tr_b16 v[48:49], v117 offset:0
    ds_read_b64_tr_b16 v[50:51], v117 offset:512
    s_waitcnt lgkmcnt(6)
    v_mfma_f32_32x32x16_bf16 v[32:47], v[68:71], a[56:59], v[32:47]
    ds_read_b64_tr_b16 v[52:53], v113 offset:0
    ds_read_b64_tr_b16 v[54:55], v113 offset:512
    s_add_u32 s94, s99, 53248
    buffer_load_dwordx4 a[8:11], v119, s[20:23], s94 offen offset:0 sc1
    s_waitcnt vmcnt(11) lgkmcnt(6)
    v_mfma_f32_32x32x16_bf16 v[16:31], v[72:75], a[60:63], v[16:31]
    ds_read_b64_tr_b16 v[56:57], v117 offset:4096
    ds_read_b64_tr_b16 v[58:59], v117 offset:4608
    s_waitcnt lgkmcnt(6)
    v_mfma_f32_32x32x16_bf16 v[32:47], v[76:79], a[60:63], v[32:47]
    ds_read_b64_tr_b16 v[60:61], v113 offset:4096
    ds_read_b64_tr_b16 v[62:63], v113 offset:4608
    buffer_load_dwordx4 a[12:15], v119, s[20:23], s94 offen offset:2048 sc1
    s_waitcnt vmcnt(11) lgkmcnt(6)
    v_mfma_f32_32x32x16_bf16 v[16:31], v[48:51], a[64:67], v[16:31]
    ds_read_b64_tr_b16 v[64:65], v117 offset:8192
    ds_read_b64_tr_b16 v[66:67], v117 offset:8704
    s_waitcnt lgkmcnt(6)
    v_mfma_f32_32x32x16_bf16 v[32:47], v[52:55], a[64:67], v[32:47]
    ds_read_b64_tr_b16 v[68:69], v113 offset:8192
    ds_read_b64_tr_b16 v[70:71], v113 offset:8704
    s_add_u32 s94, s99, 57344
    buffer_load_dwordx4 a[16:19], v119, s[20:23], s94 offen offset:0 sc1
    s_waitcnt vmcnt(11) lgkmcnt(6)
    v_mfma_f32_32x32x16_bf16 v[16:31], v[56:59], a[68:71], v[16:31]
    ds_read_b64_tr_b16 v[72:73], v117 offset:12288
    ds_read_b64_tr_b16 v[74:75], v117 offset:12800
    s_waitcnt lgkmcnt(6)
    v_mfma_f32_32x32x16_bf16 v[32:47], v[60:63], a[68:71], v[32:47]
    ds_read_b64_tr_b16 v[76:77], v113 offset:12288
    ds_read_b64_tr_b16 v[78:79], v113 offset:12800
    buffer_load_dwordx4 a[20:23], v119, s[20:23], s94 offen offset:2048 sc1
    s_waitcnt vmcnt(11) lgkmcnt(6)
    v_mfma_f32_32x32x16_bf16 v[16:31], v[64:67], a[72:75], v[16:31]
    ds_read_b64_tr_b16 v[48:49], v117 offset:16384
    ds_read_b64_tr_b16 v[50:51], v117 offset:16896
    s_waitcnt lgkmcnt(6)
    v_mfma_f32_32x32x16_bf16 v[32:47], v[68:71], a[72:75], v[32:47]
    ds_read_b64_tr_b16 v[52:53], v113 offset:16384
    ds_read_b64_tr_b16 v[54:55], v113 offset:16896
    s_add_u32 s94, s99, 61440
    buffer_load_dwordx4 a[24:27], v119, s[20:23], s94 offen offset:0 sc1
    s_waitcnt vmcnt(11) lgkmcnt(6)
    v_mfma_f32_32x32x16_bf16 v[16:31], v[72:75], a[76:79], v[16:31]
    ds_read_b64_tr_b16 v[56:57], v117 offset:20480
    ds_read_b64_tr_b16 v[58:59], v117 offset:20992
    s_waitcnt lgkmcnt(6)
    v_mfma_f32_32x32x16_bf16 v[32:47], v[76:79], a[76:79], v[32:47]
    ds_read_b64_tr_b16 v[60:61], v113 offset:20480
    ds_read_b64_tr_b16 v[62:63], v113 offset:20992
    buffer_load_dwordx4 a[28:31], v119, s[20:23], s94 offen offset:2048 sc1
    s_waitcnt vmcnt(11) lgkmcnt(6)
    v_mfma_f32_32x32x16_bf16 v[16:31], v[48:51], a[80:83], v[16:31]
    ds_read_b64_tr_b16 v[64:65], v117 offset:24576
    ds_read_b64_tr_b16 v[66:67], v117 offset:25088
    s_waitcnt lgkmcnt(6)
    v_mfma_f32_32x32x16_bf16 v[32:47], v[52:55], a[80:83], v[32:47]
    ds_read_b64_tr_b16 v[68:69], v113 offset:24576
    ds_read_b64_tr_b16 v[70:71], v113 offset:25088
    s_add_u32 s94, s99, 65536
    buffer_load_dwordx4 a[32:35], v119, s[20:23], s94 offen offset:0 sc1
    s_waitcnt vmcnt(11) lgkmcnt(6)
    v_mfma_f32_32x32x16_bf16 v[16:31], v[56:59], a[84:87], v[16:31]
    ds_read_b64_tr_b16 v[72:73], v117 offset:28672
    ds_read_b64_tr_b16 v[74:75], v117 offset:29184
    s_waitcnt lgkmcnt(6)
    v_mfma_f32_32x32x16_bf16 v[32:47], v[60:63], a[84:87], v[32:47]
    ds_read_b64_tr_b16 v[76:77], v113 offset:28672
    ds_read_b64_tr_b16 v[78:79], v113 offset:29184
    buffer_load_dwordx4 a[36:39], v119, s[20:23], s94 offen offset:2048 sc1
    s_waitcnt vmcnt(11) lgkmcnt(6)
    v_mfma_f32_32x32x16_bf16 v[16:31], v[64:67], a[88:91], v[16:31]
    ds_read_b64_tr_b16 v[48:49], v117 offset:32768
    ds_read_b64_tr_b16 v[50:51], v117 offset:33280
    s_waitcnt lgkmcnt(6)
    v_mfma_f32_32x32x16_bf16 v[32:47], v[68:71], a[88:91], v[32:47]
    ds_read_b64_tr_b16 v[52:53], v113 offset:32768
    ds_read_b64_tr_b16 v[54:55], v113 offset:33280
    s_add_u32 s94, s99, 69632
    buffer_load_dwordx4 a[40:43], v119, s[20:23], s94 offen offset:0 sc1
    s_waitcnt vmcnt(11) lgkmcnt(6)
    v_mfma_f32_32x32x16_bf16 v[16:31], v[72:75], a[92:95], v[16:31]
    ds_read_b64_tr_b16 v[56:57], v117 offset:36864
    ds_read_b64_tr_b16 v[58:59], v117 offset:37376
    s_waitcnt lgkmcnt(6)
    v_mfma_f32_32x32x16_bf16 v[32:47], v[76:79], a[92:95], v[32:47]
    ds_read_b64_tr_b16 v[60:61], v113 offset:36864
    ds_read_b64_tr_b16 v[62:63], v113 offset:37376
    buffer_load_dwordx4 a[44:47], v119, s[20:23], s94 offen offset:2048 sc1
    s_waitcnt vmcnt(11) lgkmcnt(6)
    v_mfma_f32_32x32x16_bf16 v[16:31], v[48:51], a[0:3], v[16:31]
    ds_read_b64_tr_b16 v[64:65], v117 offset:40960
    ds_read_b64_tr_b16 v[66:67], v117 offset:41472
    s_waitcnt lgkmcnt(6)
    v_mfma_f32_32x32x16_bf16 v[32:47], v[52:55], a[0:3], v[32:47]
    ds_read_b64_tr_b16 v[68:69], v113 offset:40960
    ds_read_b64_tr_b16 v[70:71], v113 offset:41472
    s_add_u32 s94, s99, 73728
    buffer_load_dwordx4 a[48:51], v119, s[20:23], s94 offen offset:0 sc1
    s_waitcnt vmcnt(11) lgkmcnt(6)
    v_mfma_f32_32x32x16_bf16 v[16:31], v[56:59], a[4:7], v[16:31]
    ds_read_b64_tr_b16 v[72:73], v117 offset:45056
    ds_read_b64_tr_b16 v[74:75], v117 offset:45568
    s_waitcnt lgkmcnt(6)
    v_mfma_f32_32x32x16_bf16 v[32:47], v[60:63], a[4:7], v[32:47]
    ds_read_b64_tr_b16 v[76:77], v113 offset:45056
    ds_read_b64_tr_b16 v[78:79], v113 offset:45568
    buffer_load_dwordx4 a[52:55], v119, s[20:23], s94 offen offset:2048 sc1
    s_barrier
    s_waitcnt vmcnt(11) lgkmcnt(6)
    v_mfma_f32_32x32x16_bf16 v[16:31], v[64:67], a[8:11], v[16:31]
    ds_read_b64_tr_b16 v[48:49], v117 offset:49152
    ds_read_b64_tr_b16 v[50:51], v117 offset:49664
    s_waitcnt lgkmcnt(6)
    v_mfma_f32_32x32x16_bf16 v[32:47], v[68:71], a[8:11], v[32:47]
    ds_read_b64_tr_b16 v[52:53], v113 offset:49152
    ds_read_b64_tr_b16 v[54:55], v113 offset:49664
    s_add_u32 s94, s99, 77824
    buffer_load_dwordx4 a[56:59], v119, s[20:23], s94 offen offset:0 sc1
    s_waitcnt vmcnt(11) lgkmcnt(6)
    v_mfma_f32_32x32x16_bf16 v[16:31], v[72:75], a[12:15], v[16:31]
    ds_read_b64_tr_b16 v[56:57], v117 offset:53248
    ds_read_b64_tr_b16 v[58:59], v117 offset:53760
    s_waitcnt lgkmcnt(6)
    v_mfma_f32_32x32x16_bf16 v[32:47], v[76:79], a[12:15], v[32:47]
    ds_read_b64_tr_b16 v[60:61], v113 offset:53248
    ds_read_b64_tr_b16 v[62:63], v113 offset:53760
    buffer_load_dwordx4 a[60:63], v119, s[20:23], s94 offen offset:2048 sc1
    s_waitcnt vmcnt(11) lgkmcnt(6)
    v_mfma_f32_32x32x16_bf16 v[16:31], v[48:51], a[16:19], v[16:31]
    ds_read_b64_tr_b16 v[64:65], v117 offset:57344
    ds_read_b64_tr_b16 v[66:67], v117 offset:57856
    s_waitcnt lgkmcnt(6)
    v_mfma_f32_32x32x16_bf16 v[32:47], v[52:55], a[16:19], v[32:47]
    ds_read_b64_tr_b16 v[68:69], v113 offset:57344
    ds_read_b64_tr_b16 v[70:71], v113 offset:57856
    s_add_u32 s94, s99, 81920
    buffer_load_dwordx4 a[64:67], v119, s[20:23], s94 offen offset:0 sc1
    s_waitcnt vmcnt(11) lgkmcnt(6)
    v_mfma_f32_32x32x16_bf16 v[16:31], v[56:59], a[20:23], v[16:31]
    ds_read_b64_tr_b16 v[72:73], v117 offset:61440
    ds_read_b64_tr_b16 v[74:75], v117 offset:61952
    s_waitcnt lgkmcnt(6)
    v_mfma_f32_32x32x16_bf16 v[32:47], v[60:63], a[20:23], v[32:47]
    ds_read_b64_tr_b16 v[76:77], v113 offset:61440
    ds_read_b64_tr_b16 v[78:79], v113 offset:61952
    buffer_load_dwordx4 a[68:71], v119, s[20:23], s94 offen offset:2048 sc1
    s_waitcnt vmcnt(11) lgkmcnt(6)
    v_mfma_f32_32x32x16_bf16 v[16:31], v[64:67], a[24:27], v[16:31]
    ds_read_b64_tr_b16 v[48:49], v118 offset:0
    ds_read_b64_tr_b16 v[50:51], v118 offset:512
    s_waitcnt lgkmcnt(6)
    v_mfma_f32_32x32x16_bf16 v[32:47], v[68:71], a[24:27], v[32:47]
    ds_read_b64_tr_b16 v[52:53], v114 offset:0
    ds_read_b64_tr_b16 v[54:55], v114 offset:512
    s_add_u32 s94, s99, 86016
    buffer_load_dwordx4 a[72:75], v119, s[20:23], s94 offen offset:0 sc1
    s_waitcnt vmcnt(11) lgkmcnt(6)
    v_mfma_f32_32x32x16_bf16 v[16:31], v[72:75], a[28:31], v[16:31]
    ds_read_b64_tr_b16 v[56:57], v118 offset:4096
    ds_read_b64_tr_b16 v[58:59], v118 offset:4608
    s_waitcnt lgkmcnt(6)
    v_mfma_f32_32x32x16_bf16 v[32:47], v[76:79], a[28:31], v[32:47]
    ds_read_b64_tr_b16 v[60:61], v114 offset:4096
    ds_read_b64_tr_b16 v[62:63], v114 offset:4608
    s_waitcnt vmcnt(10) lgkmcnt(6)
    v_mfma_f32_32x32x16_bf16 v[16:31], v[48:51], a[32:35], v[16:31]
    ds_read_b64_tr_b16 v[64:65], v118 offset:8192
    ds_read_b64_tr_b16 v[66:67], v118 offset:8704
    s_waitcnt lgkmcnt(6)
    v_mfma_f32_32x32x16_bf16 v[32:47], v[52:55], a[32:35], v[32:47]
    ds_read_b64_tr_b16 v[68:69], v114 offset:8192
    ds_read_b64_tr_b16 v[70:71], v114 offset:8704
    s_waitcnt vmcnt(9) lgkmcnt(6)
    v_mfma_f32_32x32x16_bf16 v[16:31], v[56:59], a[36:39], v[16:31]
    ds_read_b64_tr_b16 v[72:73], v118 offset:12288
    ds_read_b64_tr_b16 v[74:75], v118 offset:12800
    s_waitcnt lgkmcnt(6)
    v_mfma_f32_32x32x16_bf16 v[32:47], v[60:63], a[36:39], v[32:47]
    ds_read_b64_tr_b16 v[76:77], v114 offset:12288
    ds_read_b64_tr_b16 v[78:79], v114 offset:12800
    s_waitcnt vmcnt(8) lgkmcnt(6)
    v_mfma_f32_32x32x16_bf16 v[16:31], v[64:67], a[40:43], v[16:31]
    ds_read_b64_tr_b16 v[48:49], v118 offset:18432
    ds_read_b64_tr_b16 v[50:51], v118 offset:18944
    s_waitcnt lgkmcnt(6)
    v_mfma_f32_32x32x16_bf16 v[32:47], v[68:71], a[40:43], v[32:47]
    ds_read_b64_tr_b16 v[52:53], v114 offset:18432
    ds_read_b64_tr_b16 v[54:55], v114 offset:18944
    s_waitcnt vmcnt(7) lgkmcnt(6)
    v_mfma_f32_32x32x16_bf16 v[16:31], v[72:75], a[44:47], v[16:31]
    ds_read_b64_tr_b16 v[56:57], v118 offset:22528
    ds_read_b64_tr_b16 v[58:59], v118 offset:23040
    s_waitcnt lgkmcnt(6)
    v_mfma_f32_32x32x16_bf16 v[32:47], v[76:79], a[44:47], v[32:47]
    ds_read_b64_tr_b16 v[60:61], v114 offset:22528
    ds_read_b64_tr_b16 v[62:63], v114 offset:23040
    s_waitcnt vmcnt(6) lgkmcnt(6)
    v_mfma_f32_32x32x16_bf16 v[16:31], v[48:51], a[48:51], v[16:31]
    ds_read_b64_tr_b16 v[64:65], v116 offset:0
    ds_read_b64_tr_b16 v[66:67], v116 offset:512
    s_waitcnt lgkmcnt(6)
    v_mfma_f32_32x32x16_bf16 v[32:47], v[52:55], a[48:51], v[32:47]
    ds_read_b64_tr_b16 v[68:69], v112 offset:0
    ds_read_b64_tr_b16 v[70:71], v112 offset:512
    s_waitcnt vmcnt(5) lgkmcnt(6)
    v_mfma_f32_32x32x16_bf16 v[16:31], v[56:59], a[52:55], v[16:31]
    ds_read_b64_tr_b16 v[72:73], v116 offset:4096
    ds_read_b64_tr_b16 v[74:75], v116 offset:4608
    s_lshl_b32 s80, s70, 12
    s_add_u32 s81, s80, 32768
    v_lshlrev_b32 v12, 4, v1
    s_waitcnt lgkmcnt(6)
    v_mfma_f32_32x32x16_bf16 v[32:47], v[60:63], a[52:55], v[32:47]
    ds_read_b64_tr_b16 v[76:77], v112 offset:4096
    ds_read_b64_tr_b16 v[78:79], v112 offset:4608
    v_add_u32 v13, s81, v12
    s_xor_b32 s81, s80, 4096
    s_add_u32 s81, s81, 32768
    s_waitcnt vmcnt(4) lgkmcnt(6)
    v_mfma_f32_32x32x16_bf16 v[16:31], v[64:67], a[56:59], v[16:31]
    ds_read_b64_tr_b16 v[48:49], v116 offset:8192
    ds_read_b64_tr_b16 v[50:51], v116 offset:8704
    v_add_u32 v14, s81, v12
    s_add_u32 s81, s80, 49152
    v_add_u32 v15, s81, v12
    s_waitcnt lgkmcnt(6)
    v_mfma_f32_32x32x16_bf16 v[32:47], v[68:71], a[56:59], v[32:47]
    ds_read_b64_tr_b16 v[52:53], v112 offset:8192
    ds_read_b64_tr_b16 v[54:55], v112 offset:8704
    v_and_b32 v2, 31, v1
    v_lshrrev_b32 v3, 5, v1
    v_lshlrev_b32 v2, 10, v2
    s_waitcnt vmcnt(3) lgkmcnt(6)
    v_mfma_f32_32x32x16_bf16 v[16:31], v[72:75], a[60:63], v[16:31]
    ds_read_b64_tr_b16 v[56:57], v116 offset:12288
    ds_read_b64_tr_b16 v[58:59], v116 offset:12800
    v_lshl_add_u32 v2, v3, 4, v2
    s_lshl_b32 s82, s71, 16
    s_lshl_b32 s83, s73, 15
    s_waitcnt lgkmcnt(6)
    v_mfma_f32_32x32x16_bf16 v[32:47], v[76:79], a[60:63], v[32:47]
    ds_read_b64_tr_b16 v[60:61], v112 offset:12288
    ds_read_b64_tr_b16 v[62:63], v112 offset:12800
    s_add_u32 s82, s82, s83
    s_lshl_b32 s83, s72, 7
    s_add_u32 s82, s82, s83
    s_waitcnt vmcnt(2) lgkmcnt(6)
    v_mfma_f32_32x32x16_bf16 v[16:31], v[48:51], a[64:67], v[16:31]
    ds_read_b64_tr_b16 v[64:65], v116 offset:16384
    ds_read_b64_tr_b16 v[66:67], v116 offset:16896
    s_lshl_b32 s83, s74, 6
    s_add_u32 s82, s82, s83
    s_waitcnt lgkmcnt(6)
    v_mfma_f32_32x32x16_bf16 v[32:47], v[52:55], a[64:67], v[32:47]
    ds_read_b64_tr_b16 v[68:69], v112 offset:16384
    ds_read_b64_tr_b16 v[70:71], v112 offset:16896
    s_waitcnt vmcnt(1) lgkmcnt(6)
    v_mfma_f32_32x32x16_bf16 v[16:31], v[56:59], a[68:71], v[16:31]
    s_waitcnt lgkmcnt(4)
    v_mfma_f32_32x32x16_bf16 v[32:47], v[60:63], a[68:71], v[32:47]
    s_waitcnt vmcnt(0) lgkmcnt(2)
    v_mfma_f32_32x32x16_bf16 v[16:31], v[64:67], a[72:75], v[16:31]
    s_waitcnt lgkmcnt(0)
    v_mfma_f32_32x32x16_bf16 v[32:47], v[68:71], a[72:75], v[32:47]
    s_nop 9
    ds_write_b128 v13, v[16:19] offset:0
    ds_write_b128 v13, v[20:23] offset:1024
    ds_write_b128 v13, v[24:27] offset:2048
    ds_write_b128 v13, v[28:31] offset:3072
    s_waitcnt lgkmcnt(0)
    s_barrier
    ds_read_b128 v[64:67], v14 offset:0
    ds_read_b128 v[80:83], v15 offset:0
    ds_read_b128 v[68:71], v14 offset:1024
    ds_read_b128 v[84:87], v15 offset:1024
    ds_read_b128 v[72:75], v14 offset:2048
    ds_read_b128 v[88:91], v15 offset:2048
    ds_read_b128 v[76:79], v14 offset:3072
    ds_read_b128 v[92:95], v15 offset:3072
    s_waitcnt lgkmcnt(7)
    v_add_f32 v32, v32, v64
    v_add_f32 v33, v33, v65
    v_add_f32 v34, v34, v66
    v_add_f32 v35, v35, v67
    s_waitcnt lgkmcnt(6)
    v_add_f32 v32, v32, v80
    v_add_f32 v33, v33, v81
    v_add_f32 v34, v34, v82
    v_add_f32 v35, v35, v83
    v_cvt_pk_bf16_f32 v96, v32, v33
    v_cvt_pk_bf16_f32 v97, v34, v35
    s_waitcnt lgkmcnt(5)
    v_add_f32 v36, v36, v68
    v_add_f32 v37, v37, v69
    v_add_f32 v38, v38, v70
    v_add_f32 v39, v39, v71
    s_waitcnt lgkmcnt(4)
    v_add_f32 v36, v36, v84
    v_add_f32 v37, v37, v85
    v_add_f32 v38, v38, v86
    v_add_f32 v39, v39, v87
    v_cvt_pk_bf16_f32 v98, v36, v37
    v_cvt_pk_bf16_f32 v99, v38, v39
    s_nop 0
    v_permlane32_swap_b32 v96, v98
    v_permlane32_swap_b32 v97, v99
    buffer_store_dwordx4 v[96:99], v2, s[24:27], s82 offen offset:0
    s_waitcnt lgkmcnt(3)
    v_add_f32 v40, v40, v72
    v_add_f32 v41, v41, v73
    v_add_f32 v42, v42, v74
    v_add_f32 v43, v43, v75
    s_waitcnt lgkmcnt(2)
    v_add_f32 v40, v40, v88
    v_add_f32 v41, v41, v89
    v_add_f32 v42, v42, v90
    v_add_f32 v43, v43, v91
    v_cvt_pk_bf16_f32 v100, v40, v41
    v_cvt_pk_bf16_f32 v101, v42, v43
    s_waitcnt lgkmcnt(1)
    v_add_f32 v44, v44, v76
    v_add_f32 v45, v45, v77
    v_add_f32 v46, v46, v78
    v_add_f32 v47, v47, v79
    s_waitcnt lgkmcnt(0)
    v_add_f32 v44, v44, v92
    v_add_f32 v45, v45, v93
    v_add_f32 v46, v46, v94
    v_add_f32 v47, v47, v95
    v_cvt_pk_bf16_f32 v102, v44, v45
    v_cvt_pk_bf16_f32 v103, v46, v47
    s_nop 0
    v_permlane32_swap_b32 v100, v102
    v_permlane32_swap_b32 v101, v103
    buffer_store_dwordx4 v[100:103], v2, s[24:27], s82 offen offset:32
    s_endpgm
L_helper:
    s_cmp_lg_u32 s2, 0
    s_cbranch_scc1 L_nw_1
    s_cmp_lg_u32 s70, 0
    s_cbranch_scc1 L_nw_1
    s_memrealtime s[80:81]
    s_waitcnt lgkmcnt(0)
    s_or_b32 s80, s80, 1
    v_mov_b32 v8, s80
    v_mov_b32 v9, 0
    s_mov_b64 exec, 1
    buffer_store_dword v8, v9, s[28:31], 0 offen sc1
    s_mov_b64 exec, -1
    s_nop 1
L_nw_1:
    v_lshrrev_b32 v2, 2, v1
    v_and_b32 v3, 3, v1
    v_lshlrev_b32 v3, 4, v3
    v_mul_u32_u24 v116, 2752, v2
    v_add_u32 v116, v116, v3
    v_add_u32 v117, 64, v116
    v_add_u32 v118, 128, v116
    v_lshrrev_b32 v2, 3, v1
    v_lshrrev_b32 v3, 4, v1
    v_and_b32 v3, 1, v3
    v_lshlrev_b32 v3, 2, v3
    v_and_b32 v4, 7, v1
    v_xor_b32 v3, v3, v4
    v_lshlrev_b32 v3, 4, v3
    v_lshl_add_u32 v119, v2, 10, v3
    v_add_u32 v120, 7168, v119
    s_mul_i32 s96, s74, 44032
    s_mul_i32 s80, s73, 3
    s_add_u32 s80, s80, s77
    s_lshl_b32 s80, s80, 6
    s_add_u32 s96, s96, s80
    s_mul_i32 s54, s73, 6144
    s_lshl_b32 s80, s74, 10
    s_add_u32 s54, s54, s80
    s_lshl_b32 s97, s70, 11
    s_lshl_b32 s98, s70, 14
    s_lshl_b32 s80, s72, 7
    s_add_u32 s98, s98, s80
    v_lshlrev_b32 v121, 4, v1
    s_lshl_b32 s80, s70, 14
    s_lshl_b32 s55, s71, 16
    s_add_u32 s55, s55, s80
    v_lshrrev_b32 v2, 3, v1
    v_lshrrev_b32 v3, 4, v1
    v_and_b32 v90, 7, v1
    v_xor_b32 v90, v90, v3
    v_lshlrev_b32 v90, 4, v90
    v_lshl_add_u32 v90, v2, 10, v90
    v_xor_b32 v91, 64, v90
    v_add_u32 v91, 8192, v91
    s_lshl_b32 s94, s70, 11
    s_add_u32 m0, s94, 0
    s_nop 0
    buffer_load_dwordx4 v90, s[8:11], s55 offen offset:0 lds
    s_add_u32 m0, s94, 1024
    s_nop 0
    buffer_load_dwordx4 v91, s[8:11], s55 offen offset:0 lds
    s_add_u32 m0, s94, 8064
    s_nop 0
    buffer_load_dwordx4 v90, s[8:11], s55 offen offset:128 lds
    s_add_u32 m0, s94, 9088
    s_nop 0
    buffer_load_dwordx4 v91, s[8:11], s55 offen offset:128 lds
    s_add_u32 m0, s94, 16128
    s_nop 0
    buffer_load_dwordx4 v90, s[8:11], s55 offen offset:256 lds
    s_add_u32 m0, s94, 17152
    s_nop 0
    buffer_load_dwordx4 v91, s[8:11], s55 offen offset:256 lds
    s_add_u32 m0, s94, 24192
    s_nop 0
    buffer_load_dwordx4 v90, s[8:11], s55 offen offset:384 lds
    s_add_u32 m0, s94, 25216
    s_nop 0
    buffer_load_dwordx4 v91, s[8:11], s55 offen offset:384 lds
    s_add_u32 m0, s94, 32256
    s_nop 0
    buffer_load_dwordx4 v90, s[8:11], s55 offen offset:512 lds
    s_add_u32 m0, s94, 33280
    s_nop 0
    buffer_load_dwordx4 v91, s[8:11], s55 offen offset:512 lds
    s_add_u32 m0, s94, 40320
    s_nop 0
    buffer_load_dwordx4 v90, s[8:11], s55 offen offset:640 lds
    s_add_u32 m0, s94, 41344
    s_nop 0
    buffer_load_dwordx4 v91, s[8:11], s55 offen offset:640 lds
    s_add_u32 m0, s94, 48384
    s_nop 0
    buffer_load_dwordx4 v90, s[8:11], s55 offen offset:768 lds
    s_add_u32 m0, s94, 49408
    s_nop 0
    buffer_load_dwordx4 v91, s[8:11], s55 offen offset:768 lds
    s_add_u32 m0, s94, 56448
    s_nop 0
    buffer_load_dwordx4 v90, s[8:11], s55 offen offset:896 lds
    s_add_u32 m0, s94, 57472
    s_nop 0
    buffer_load_dwordx4 v91, s[8:11], s55 offen offset:896 lds
    s_add_u32 s95, s96, 0
    s_add_u32 m0, s54, 65536
    s_nop 0
    buffer_load_dwordx4 v116, s[12:15], s95 offen lds
    s_add_u32 m0, s54, 67584
    s_nop 0
    buffer_load_dwordx4 v117, s[12:15], s95 offen lds
    s_add_u32 m0, s54, 69632
    s_nop 0
    buffer_load_dwordx4 v118, s[12:15], s95 offen lds
    s_add_u32 s95, s96, 88064
    s_add_u32 m0, s54, 77824
    s_nop 0
    buffer_load_dwordx4 v116, s[12:15], s95 offen lds
    s_add_u32 m0, s54, 79872
    s_nop 0
    buffer_load_dwordx4 v117, s[12:15], s95 offen lds
    s_add_u32 m0, s54, 81920
    s_nop 0
    buffer_load_dwordx4 v118, s[12:15], s95 offen lds
    v_mov_b32 v123, 0
    buffer_load_dword v122, v123, s[28:31], 0 offen sc1
    v_mov_b32 v20, -1
    v_mov_b32 v21, -1
    v_mov_b32 v22, -1
    v_mov_b32 v23, -1
    v_lshrrev_b32 v115, 3, v1
    s_lshl_b32 s80, s72, 6
    s_lshl_b32 s81, s70, 4
    s_add_u32 s80, s80, s81
    v_add_u32 v115, s80, v115
    v_mul_u32_u24 v115, 4096, v115
    v_and_b32 v8, 7, v1
    v_lshl_add_u32 v115, v8, 4, v115
    s_lshl_b32 s80, s71, 7
    s_add_u32 s48, s80, 1048576
    s_add_u32 s49, s48, 32768
    s_mul_i32 s86, s76, 4096
    s_lshl_b32 s81, s74, 11
    s_add_u32 s86, s86, s81
    s_add_u32 s86, s86, 10485760
    buffer_store_dwordx4 v[20:23], v115, s[20:23], s48 offen sc1
    buffer_store_dwordx4 v[20:23], v115, s[20:23], s49 offen sc1
    buffer_store_dwordx4 v[20:23], v121, s[20:23], s86 offen offset:0 sc1
    buffer_store_dwordx4 v[20:23], v121, s[20:23], s86 offen offset:1024 sc1
    s_and_b32 s80, s76, 0x1fe
    s_lshl_b32 s80, s80, 1
    s_load_dword s42, s[52:53], s80
    s_mov_b32 s88, s58
    s_mov_b32 s89, s59
    s_mov_b32 s90, 0xac0
    s_mov_b32 s91, 0x20000
    s_lshl_b32 s80, s77, 6
    s_lshl_b32 s81, s70, 7
    s_add_u32 s80, s80, s81
    v_lshlrev_b32 v2, 1, v1
    v_add_u32 v2, s80, v2
    buffer_load_ushort v114, v2, s[88:91], 0 offen
    v_lshrrev_b32 v3, 5, v1
    s_lshl_b32 s82, s72, 7
    s_lshl_b32 s81, s74, 6
    s_add_u32 s82, s82, s81
    v_lshlrev_b32 v3, 3, v3
    v_add_u32 v3, s82, v3
    global_load_dwordx2 v[100:101], v3, s[62:63] offset:0
    global_load_dwordx2 v[102:103], v3, s[62:63] offset:16
    global_load_dwordx2 v[104:105], v3, s[62:63] offset:32
    global_load_dwordx2 v[106:107], v3, s[62:63] offset:48
    v_lshrrev_b32 v3, 4, v1
    v_lshrrev_b32 v33, 2, v1
    v_and_b32 v33, 3, v33
    v_and_b32 v34, 3, v1
    v_lshl_add_u32 v35, v3, 3, v33
    s_lshl_b32 s83, s70, 1
    v_lshrrev_b32 v36, 1, v34
    v_add_u32 v36, s83, v36
    v_lshrrev_b32 v37, 1, v35
    v_and_b32 v37, 7, v37
    v_xor_b32 v36, v36, v37
    v_lshlrev_b32 v36, 4, v36
    v_lshl_add_u32 v36, v35, 7, v36
    v_and_b32 v37, 1, v34
    v_lshl_add_u32 v36, v37, 3, v36
    s_lshl_b32 s82, s72, 13
    v_add_u32 v108, s82, v36
    v_add_u32 v109, 512, v108
    v_xor_b32 v109, 32, v109
    v_lshlrev_b32 v98, 5, v3
    v_add_u32 v98, 158720, v98
    v_and_b32 v2, 31, v1
    v_lshrrev_b32 v3, 5, v1
    v_lshrrev_b32 v33, 1, v2
    v_and_b32 v33, 7, v33
    s_lshl_b32 s80, s74, 2
    v_xor_b32 v33, s80, v33
    v_lshlrev_b32 v33, 4, v33
    v_lshl_add_u32 v33, v3, 3, v33
    v_lshl_add_u32 v33, v2, 7, v33
    s_lshl_b32 s80, s73, 12
    s_lshl_b32 s81, s72, 13
    s_add_u32 s80, s80, s81
    v_add_u32 v110, s80, v33
    v_xor_b32 v111, 16, v110
    v_xor_b32 v112, 32, v110
    v_xor_b32 v113, 48, v110
    s_mul_i32 s80, s70, 8704
    s_add_u32 s80, s80, 118784
    v_and_b32 v2, 15, v1
    v_lshrrev_b32 v3, 4, v1
    v_and_b32 v4, 7, v2
    v_xor_b32 v3, v3, v4
    v_lshlrev_b32 v3, 4, v3
    v_lshl_add_u32 v3, v2, 7, v3
    v_add_u32 v96, s80, v3
    v_lshrrev_b32 v2, 3, v1
    v_and_b32 v3, 7, v1
    v_xor_b32 v3, v3, v2
    v_lshlrev_b32 v3, 4, v3
    v_lshl_add_u32 v3, v2, 7, v3
    v_add_u32 v97, s80, v3
    v_and_b32 v2, 15, v1
    v_lshrrev_b32 v3, 4, v1
    v_lshrrev_b32 v4, 1, v2
    v_xor_b32 v4, v4, v3
    v_lshlrev_b32 v4, 4, v4
    s_lshl_b32 s80, s70, 11
    v_lshl_add_u32 v4, v2, 7, v4
    v_add_u32 v6, s80, v4
    v_xor_b32 v7, 64, v6
    v_mov_b32 v12, 0x3f803f80
    v_mov_b32 v13, 0x3f803f80
    v_mov_b32 v14, 0x3f803f80
    v_mov_b32 v15, 0x3f803f80
    s_waitcnt vmcnt(30)
    ds_read_b128 a[0:3], v6 offset:0
    ds_read_b128 a[4:7], v7 offset:0
    s_waitcnt vmcnt(28)
    ds_read_b128 a[8:11], v6 offset:8192
    ds_read_b128 a[12:15], v7 offset:8192
    s_waitcnt lgkmcnt(0)
    v_mfma_f32_16x16x32_bf16 v[16:19], a[0:3], a[0:3], 0
    v_mfma_f32_16x16x32_bf16 v[20:23], a[0:3], v[12:15], 0
    v_mfma_f32_16x16x32_bf16 v[16:19], a[4:7], a[4:7], v[16:19]
    v_mfma_f32_16x16x32_bf16 v[20:23], a[4:7], v[12:15], v[20:23]
    s_waitcnt vmcnt(26)
    ds_read_b128 a[16:19], v6 offset:16384
    ds_read_b128 a[20:23], v7 offset:16384
    v_mfma_f32_16x16x32_bf16 v[16:19], a[8:11], a[8:11], v[16:19]
    v_mfma_f32_16x16x32_bf16 v[20:23], a[8:11], v[12:15], v[20:23]
    v_mfma_f32_16x16x32_bf16 v[16:19], a[12:15], a[12:15], v[16:19]
    v_mfma_f32_16x16x32_bf16 v[20:23], a[12:15], v[12:15], v[20:23]
    s_waitcnt vmcnt(24)
    ds_read_b128 a[24:27], v6 offset:24576
    ds_read_b128 a[28:31], v7 offset:24576
    s_waitcnt lgkmcnt(3)
    v_mfma_f32_16x16x32_bf16 v[16:19], a[16:19], a[16:19], v[16:19]
    v_mfma_f32_16x16x32_bf16 v[20:23], a[16:19], v[12:15], v[20:23]
    s_waitcnt lgkmcnt(2)
    v_mfma_f32_16x16x32_bf16 v[16:19], a[20:23], a[20:23], v[16:19]
    v_mfma_f32_16x16x32_bf16 v[20:23], a[20:23], v[12:15], v[20:23]
    s_waitcnt vmcnt(22)
    ds_read_b128 a[32:35], v6 offset:32768
    ds_read_b128 a[36:39], v7 offset:32768
    s_waitcnt lgkmcnt(3)
    v_mfma_f32_16x16x32_bf16 v[16:19], a[24:27], a[24:27], v[16:19]
    v_mfma_f32_16x16x32_bf16 v[20:23], a[24:27], v[12:15], v[20:23]
    s_waitcnt lgkmcnt(2)
    v_mfma_f32_16x16x32_bf16 v[16:19], a[28:31], a[28:31], v[16:19]
    v_mfma_f32_16x16x32_bf16 v[20:23], a[28:31], v[12:15], v[20:23]
    s_waitcnt vmcnt(20)
    ds_read_b128 a[40:43], v6 offset:40960
    ds_read_b128 a[44:47], v7 offset:40960
    s_waitcnt lgkmcnt(3)
    v_mfma_f32_16x16x32_bf16 v[16:19], a[32:35], a[32:35], v[16:19]
    v_mfma_f32_16x16x32_bf16 v[20:23], a[32:35], v[12:15], v[20:23]
    s_waitcnt lgkmcnt(2)
    v_mfma_f32_16x16x32_bf16 v[16:19], a[36:39], a[36:39], v[16:19]
    v_mfma_f32_16x16x32_bf16 v[20:23], a[36:39], v[12:15], v[20:23]
    s_waitcnt vmcnt(18)
    ds_read_b128 a[48:51], v6 offset:49152
    ds_read_b128 a[52:55], v7 offset:49152
    s_waitcnt lgkmcnt(3)
    v_mfma_f32_16x16x32_bf16 v[16:19], a[40:43], a[40:43], v[16:19]
    v_mfma_f32_16x16x32_bf16 v[20:23], a[40:43], v[12:15], v[20:23]
    s_waitcnt lgkmcnt(2)
    v_mfma_f32_16x16x32_bf16 v[16:19], a[44:47], a[44:47], v[16:19]
    v_mfma_f32_16x16x32_bf16 v[20:23], a[44:47], v[12:15], v[20:23]
    s_waitcnt vmcnt(16)
    ds_read_b128 a[56:59], v6 offset:57344
    ds_read_b128 a[60:63], v7 offset:57344
    s_waitcnt lgkmcnt(3)
    v_mfma_f32_16x16x32_bf16 v[16:19], a[48:51], a[48:51], v[16:19]
    v_mfma_f32_16x16x32_bf16 v[20:23], a[48:51], v[12:15], v[20:23]
    s_waitcnt lgkmcnt(2)
    v_mfma_f32_16x16x32_bf16 v[16:19], a[52:55], a[52:55], v[16:19]
    v_mfma_f32_16x16x32_bf16 v[20:23], a[52:55], v[12:15], v[20:23]
    s_waitcnt lgkmcnt(1)
    v_mfma_f32_16x16x32_bf16 v[16:19], a[56:59], a[56:59], v[16:19]
    v_mfma_f32_16x16x32_bf16 v[20:23], a[56:59], v[12:15], v[20:23]
    s_waitcnt lgkmcnt(0)
    v_mfma_f32_16x16x32_bf16 v[16:19], a[60:63], a[60:63], v[16:19]
    v_mfma_f32_16x16x32_bf16 v[20:23], a[60:63], v[12:15], v[20:23]
    v_and_b32 v2, 15, v1
    v_and_b32 v5, 3, v2
    s_nop 4
    v_mov_b32 v10, v16
    v_mov_b32 v11, v20
    v_cmp_eq_u32 vcc, 1, v5
    s_nop 1
    v_cndmask_b32 v10, v10, v17, vcc
    v_cndmask_b32 v11, v11, v21, vcc
    v_cmp_eq_u32 vcc, 2, v5
    s_nop 1
    v_cndmask_b32 v10, v10, v18, vcc
    v_cndmask_b32 v11, v11, v22, vcc
    v_cmp_eq_u32 vcc, 3, v5
    s_nop 1
    v_cndmask_b32 v10, v10, v19, vcc
    v_cndmask_b32 v11, v11, v23, vcc
    v_mul_f32 v11, 0x3b000000, v11
    v_mul_f32 v10, 0x3b000000, v10
    v_fma_f32 v10, -v11, v11, v10
    v_max_f32 v10, 0, v10
    v_cvt_pk_bf16_f32 v32, v11, v10
    v_and_b32 v10, 0xffff0000, v32
    v_lshlrev_b32 v11, 16, v32
    v_add_f32 v10, 0x3727c5ac, v10
    v_cvt_pk_bf16_f32 v10, v10, v10
    v_lshlrev_b32 v10, 16, v10
    v_sqrt_f32 v10, v10
    s_lshl_b32 s80, s70, 6
    v_lshlrev_b32 v4, 2, v2
    v_cvt_pk_bf16_f32 v10, v10, v10
    v_lshlrev_b32 v10, 16, v10
    v_rcp_f32 v10, v10
    v_add_u32 v4, s80, v4
    v_add_u32 v4, 158720, v4
    v_mul_f32 v11, v11, v10
    v_sub_f32 v11, 0, v11
    s_mov_b32 exec_lo, 0x00f0000f
    s_mov_b32 exec_hi, 0xf0000f00
    ds_write_b32 v4, v10
    ds_write_b32 v4, v11 offset:256
    s_mov_b64 exec, -1
    s_add_u32 s95, s96, 176128
    s_add_u32 m0, s54, 90112
    s_nop 0
    buffer_load_dwordx4 v116, s[12:15], s95 offen lds
    s_add_u32 m0, s54, 92160
    s_nop 0
    buffer_load_dwordx4 v117, s[12:15], s95 offen lds
    s_add_u32 m0, s54, 94208
    s_nop 0
    buffer_load_dwordx4 v118, s[12:15], s95 offen lds
    s_add_u32 s95, s96, 264192
    s_add_u32 m0, s54, 102400
    s_nop 0
    buffer_load_dwordx4 v116, s[12:15], s95 offen lds
    s_add_u32 m0, s54, 104448
    s_nop 0
    buffer_load_dwordx4 v117, s[12:15], s95 offen lds
    s_add_u32 m0, s54, 106496
    s_nop 0
    buffer_load_dwordx4 v118, s[12:15], s95 offen lds
    s_lshl_b32 s80, s70, 8
    s_add_u32 s80, s80, 159232
    v_lshlrev_b32 v2, 2, v1
    v_add_u32 v2, s80, v2
    s_waitcnt vmcnt(10)
    v_lshlrev_b32 v114, 16, v114
    ds_write_b32 v2, v114
    v_readfirstlane_b32 s75, v122
    s_nop 1
    s_cmp_lg_u32 s75, 0
    s_cbranch_scc1 L_nc_2
    s_mov_b32 s80, 0
L_nl_3:
    buffer_load_dword v122, v123, s[28:31], 0 offen sc1
    s_waitcnt vmcnt(0)
    v_readfirstlane_b32 s75, v122
    s_add_u32 s80, s80, 1
    s_cmp_gt_u32 s80, 30000
    s_cbranch_scc1 L_nc_2
    s_cmp_eq_u32 s75, 0
    s_cbranch_scc1 L_nl_3
L_nc_2:
    v_mov_b32 v8, s75
    v_mov_b32 v9, 162304
    s_mov_b64 exec, 1
    ds_write_b32 v9, v8
    s_mov_b64 exec, -1
    s_waitcnt lgkmcnt(0)
    s_waitcnt lgkmcnt(0)
    s_barrier
    s_cmp_lg_u32 s70, 0
    s_cbranch_scc1 L_fs_4
    s_lshl_b32 s80, s72, 7
    s_lshl_b32 s81, s71, 2
    s_add_u32 s80, s80, s81
    s_add_u32 s80, s80, 0
    v_mov_b32 v8, s75
    v_mov_b32 v9, s80
    s_mov_b64 exec, 1
    buffer_store_dword v8, v9, s[20:23], 0 offen sc1
    s_mov_b64 exec, -1
    s_nop 1
L_fs_4:
    ds_read_b64 v[80:81], v110 offset:0
    ds_read_b64 v[82:83], v111 offset:0
    ds_read_b64 v[84:85], v112 offset:0
    ds_read_b64 v[86:87], v113 offset:0
    s_cmp_eq_u32 s73, 0
    s_cbranch_scc0 L_worker
L_loader:
    s_waitcnt lgkmcnt(0)
    s_waitcnt vmcnt(3)
    s_barrier
    s_add_u32 s95, s96, 352256
    s_add_u32 m0, s54, 65536
    s_nop 0
    buffer_load_dwordx4 v116, s[12:15], s95 offen lds
    s_add_u32 m0, s54, 67584
    s_nop 0
    buffer_load_dwordx4 v117, s[12:15], s95 offen lds
    s_add_u32 m0, s54, 69632
    s_nop 0
    buffer_load_dwordx4 v118, s[12:15], s95 offen lds
    s_add_u32 s95, s96, 352448
    s_add_u32 m0, s54, 71680
    s_nop 0
    buffer_load_dwordx4 v116, s[12:15], s95 offen lds
    s_add_u32 m0, s54, 73728
    s_nop 0
    buffer_load_dwordx4 v117, s[12:15], s95 offen lds
    s_add_u32 m0, s54, 75776
    s_nop 0
    buffer_load_dwordx4 v118, s[12:15], s95 offen lds
    s_add_u32 s95, s96, 440320
    s_add_u32 m0, s54, 0
    s_nop 0
    buffer_load_dwordx4 v116, s[12:15], s95 offen lds
    s_add_u32 m0, s54, 2048
    s_nop 0
    buffer_load_dwordx4 v117, s[12:15], s95 offen lds
    s_add_u32 m0, s54, 4096
    s_nop 0
    buffer_load_dwordx4 v118, s[12:15], s95 offen lds
    s_add_u32 s95, s96, 440512
    s_add_u32 m0, s54, 6144
    s_nop 0
    buffer_load_dwordx4 v116, s[12:15], s95 offen lds
    s_add_u32 m0, s54, 8192
    s_nop 0
    buffer_load_dwordx4 v117, s[12:15], s95 offen lds
    s_add_u32 m0, s54, 10240
    s_nop 0
    buffer_load_dwordx4 v118, s[12:15], s95 offen lds
    s_waitcnt vmcnt(12)
    s_barrier
    s_add_u32 s95, s96, 528384
    s_add_u32 m0, s54, 77824
    s_nop 0
    buffer_load_dwordx4 v116, s[12:15], s95 offen lds
    s_add_u32 m0, s54, 79872
    s_nop 0
    buffer_load_dwordx4 v117, s[12:15], s95 offen lds
    s_add_u32 m0, s54, 81920
    s_nop 0
    buffer_load_dwordx4 v118, s[12:15], s95 offen lds
    s_add_u32 s95, s96, 528576
    s_add_u32 m0, s54, 83968
    s_nop 0
    buffer_load_dwordx4 v116, s[12:15], s95 offen lds
    s_add_u32 m0, s54, 86016
    s_nop 0
    buffer_load_dwordx4 v117, s[12:15], s95 offen lds
    s_add_u32 m0, s54, 88064
    s_nop 0
    buffer_load_dwordx4 v118, s[12:15], s95 offen lds
    s_add_u32 s95, s96, 616448
    s_add_u32 m0, s54, 12288
    s_nop 0
    buffer_load_dwordx4 v116, s[12:15], s95 offen lds
    s_add_u32 m0, s54, 14336
    s_nop 0
    buffer_load_dwordx4 v117, s[12:15], s95 offen lds
    s_add_u32 m0, s54, 16384
    s_nop 0
    buffer_load_dwordx4 v118, s[12:15], s95 offen lds
    s_add_u32 s95, s96, 616640
    s_add_u32 m0, s54, 18432
    s_nop 0
    buffer_load_dwordx4 v116, s[12:15], s95 offen lds
    s_add_u32 m0, s54, 20480
    s_nop 0
    buffer_load_dwordx4 v117, s[12:15], s95 offen lds
    s_add_u32 m0, s54, 22528
    s_nop 0
    buffer_load_dwordx4 v118, s[12:15], s95 offen lds
    s_waitcnt vmcnt(18)
    s_barrier
    s_add_u32 s95, s96, 704512
    s_add_u32 m0, s54, 90112
    s_nop 0
    buffer_load_dwordx4 v116, s[12:15], s95 offen lds
    s_add_u32 m0, s54, 92160
    s_nop 0
    buffer_load_dwordx4 v117, s[12:15], s95 offen lds
    s_add_u32 m0, s54, 94208
    s_nop 0
    buffer_load_dwordx4 v118, s[12:15], s95 offen lds
    s_add_u32 s95, s96, 704704
    s_add_u32 m0, s54, 96256
    s_nop 0
    buffer_load_dwordx4 v116, s[12:15], s95 offen lds
    s_add_u32 m0, s54, 98304
    s_nop 0
    buffer_load_dwordx4 v117, s[12:15], s95 offen lds
    s_add_u32 m0, s54, 100352
    s_nop 0
    buffer_load_dwordx4 v118, s[12:15], s95 offen lds
    s_waitcnt vmcnt(18)
    s_barrier
    s_add_u32 s95, s96, 792576
    s_add_u32 m0, s54, 24576
    s_nop 0
    buffer_load_dwordx4 v116, s[12:15], s95 offen lds
    s_add_u32 m0, s54, 26624
    s_nop 0
    buffer_load_dwordx4 v117, s[12:15], s95 offen lds
    s_add_u32 m0, s54, 28672
    s_nop 0
    buffer_load_dwordx4 v118, s[12:15], s95 offen lds
    s_add_u32 s95, s96, 792768
    s_add_u32 m0, s54, 30720
    s_nop 0
    buffer_load_dwordx4 v116, s[12:15], s95 offen lds
    s_add_u32 m0, s54, 32768
    s_nop 0
    buffer_load_dwordx4 v117, s[12:15], s95 offen lds
    s_add_u32 m0, s54, 34816
    s_nop 0
    buffer_load_dwordx4 v118, s[12:15], s95 offen lds
    s_waitcnt vmcnt(18)
    s_barrier
    s_add_u32 s95, s96, 880640
    s_add_u32 m0, s54, 102400
    s_nop 0
    buffer_load_dwordx4 v116, s[12:15], s95 offen lds
    s_add_u32 m0, s54, 104448
    s_nop 0
    buffer_load_dwordx4 v117, s[12:15], s95 offen lds
    s_add_u32 m0, s54, 106496
    s_nop 0
    buffer_load_dwordx4 v118, s[12:15], s95 offen lds
    s_add_u32 s95, s96, 880832
    s_add_u32 m0, s54, 108544
    s_nop 0
    buffer_load_dwordx4 v116, s[12:15], s95 offen lds
    s_add_u32 m0, s54, 110592
    s_nop 0
    buffer_load_dwordx4 v117, s[12:15], s95 offen lds
    s_add_u32 m0, s54, 112640
    s_nop 0
    buffer_load_dwordx4 v118, s[12:15], s95 offen lds
    s_waitcnt vmcnt(18)
    s_barrier
    s_add_u32 s95, s96, 968704
    s_add_u32 m0, s54, 36864
    s_nop 0
    buffer_load_dwordx4 v116, s[12:15], s95 offen lds
    s_add_u32 m0, s54, 38912
    s_nop 0
    buffer_load_dwordx4 v117, s[12:15], s95 offen lds
    s_add_u32 m0, s54, 40960
    s_nop 0
    buffer_load_dwordx4 v118, s[12:15], s95 offen lds
    s_add_u32 s95, s96, 968896
    s_add_u32 m0, s54, 43008
    s_nop 0
    buffer_load_dwordx4 v116, s[12:15], s95 offen lds
    s_add_u32 m0, s54, 45056
    s_nop 0
    buffer_load_dwordx4 v117, s[12:15], s95 offen lds
    s_add_u32 m0, s54, 47104
    s_nop 0
    buffer_load_dwordx4 v118, s[12:15], s95 offen lds
    s_waitcnt vmcnt(18)
    s_barrier
    s_add_u32 s95, s96, 1056768
    s_add_u32 m0, s54, 65536
    s_nop 0
    buffer_load_dwordx4 v116, s[12:15], s95 offen lds
    s_add_u32 m0, s54, 67584
    s_nop 0
    buffer_load_dwordx4 v117, s[12:15], s95 offen lds
    s_add_u32 m0, s54, 69632
    s_nop 0
    buffer_load_dwordx4 v118, s[12:15], s95 offen lds
    s_add_u32 s95, s96, 1056960
    s_add_u32 m0, s54, 71680
    s_nop 0
    buffer_load_dwordx4 v116, s[12:15], s95 offen lds
    s_add_u32 m0, s54, 73728
    s_nop 0
    buffer_load_dwordx4 v117, s[12:15], s95 offen lds
    s_add_u32 m0, s54, 75776
    s_nop 0
    buffer_load_dwordx4 v118, s[12:15], s95 offen lds
    s_waitcnt vmcnt(18)
    s_barrier
    s_add_u32 s95, s96, 1144832
    s_add_u32 m0, s54, 0
    s_nop 0
    buffer_load_dwordx4 v116, s[12:15], s95 offen lds
    s_add_u32 m0, s54, 2048
    s_nop 0
    buffer_load_dwordx4 v117, s[12:15], s95 offen lds
    s_add_u32 m0, s54, 4096
    s_nop 0
    buffer_load_dwordx4 v118, s[12:15], s95 offen lds
    s_add_u32 s95, s96, 1145024
    s_add_u32 m0, s54, 6144
    s_nop 0
    buffer_load_dwordx4 v116, s[12:15], s95 offen lds
    s_add_u32 m0, s54, 8192
    s_nop 0
    buffer_load_dwordx4 v117, s[12:15], s95 offen lds
    s_add_u32 m0, s54, 10240
    s_nop 0
    buffer_load_dwordx4 v118, s[12:15], s95 offen lds
    s_waitcnt vmcnt(18)
    s_barrier
    s_add_u32 s95, s96, 1232896
    s_add_u32 m0, s54, 77824
    s_nop 0
    buffer_load_dwordx4 v116, s[12:15], s95 offen lds
    s_add_u32 m0, s54, 79872
    s_nop 0
    buffer_load_dwordx4 v117, s[12:15], s95 offen lds
    s_add_u32 m0, s54, 81920
    s_nop 0
    buffer_load_dwordx4 v118, s[12:15], s95 offen lds
    s_add_u32 s95, s96, 1233088
    s_add_u32 m0, s54, 83968
    s_nop 0
    buffer_load_dwordx4 v116, s[12:15], s95 offen lds
    s_add_u32 m0, s54, 86016
    s_nop 0
    buffer_load_dwordx4 v117, s[12:15], s95 offen lds
    s_add_u32 m0, s54, 88064
    s_nop 0
    buffer_load_dwordx4 v118, s[12:15], s95 offen lds
    s_waitcnt vmcnt(18)
    s_barrier
    s_add_u32 s95, s96, 1320960
    s_add_u32 m0, s54, 12288
    s_nop 0
    buffer_load_dwordx4 v116, s[12:15], s95 offen lds
    s_add_u32 m0, s54, 14336
    s_nop 0
    buffer_load_dwordx4 v117, s[12:15], s95 offen lds
    s_add_u32 m0, s54, 16384
    s_nop 0
    buffer_load_dwordx4 v118, s[12:15], s95 offen lds
    s_add_u32 s95, s96, 1321152
    s_add_u32 m0, s54, 18432
    s_nop 0
    buffer_load_dwordx4 v116, s[12:15], s95 offen lds
    s_add_u32 m0, s54, 20480
    s_nop 0
    buffer_load_dwordx4 v117, s[12:15], s95 offen lds
    s_add_u32 m0, s54, 22528
    s_nop 0
    buffer_load_dwordx4 v118, s[12:15], s95 offen lds
    s_waitcnt vmcnt(18)
    s_barrier
    s_branch L_join
L_worker:
    s_nop 1
    s_lshl_b32 s80, s74, 5
    s_sub_u32 s80, 64, s80
    v_xor_b32 v108, s80, v108
    v_xor_b32 v109, s80, v109
    v_xor_b32 v10, 32, v108
    v_xor_b32 v11, 32, v109
    ds_read_b64_tr_b16 v[24:25], v108 offset:0
    ds_read_b64_tr_b16 v[26:27], v109 offset:0
    ds_read_b64_tr_b16 v[28:29], v108 offset:4096
    ds_read_b64_tr_b16 v[30:31], v109 offset:4096
    ds_read_b64_tr_b16 v[16:17], v10 offset:0
    ds_read_b64_tr_b16 v[18:19], v11 offset:0
    ds_read_b64_tr_b16 v[20:21], v10 offset:4096
    ds_read_b64_tr_b16 v[22:23], v11 offset:4096
    ds_read_b128 v[32:35], v98 offset:0
    ds_read_b128 v[48:51], v98 offset:256
    ds_read_b128 v[36:39], v98 offset:16
    ds_read_b128 v[52:55], v98 offset:272
    ds_read_b128 v[40:43], v98 offset:128
    ds_read_b128 v[56:59], v98 offset:384
    ds_read_b128 v[44:47], v98 offset:144
    ds_read_b128 v[60:63], v98 offset:400
    s_mul_i32 s80, s74, 65536
    s_add_u32 s48, s48, s80
    s_sub_u32 s48, s48, 131072
    s_add_u32 s49, s48, 32768
    s_add_u32 s84, s48, 65536
    s_add_u32 s85, s48, 98304
    s_waitcnt lgkmcnt(0)
    s_waitcnt vmcnt(3)
    s_barrier
    v_lshlrev_b32 v64, 16, v24
    v_and_b32 v65, 0xffff0000, v24
    v_lshlrev_b32 v66, 16, v25
    v_and_b32 v67, 0xffff0000, v25
    v_lshlrev_b32 v68, 16, v26
    v_and_b32 v69, 0xffff0000, v26
    v_lshlrev_b32 v70, 16, v27
    v_and_b32 v71, 0xffff0000, v27
    v_lshlrev_b32 v72, 16, v28
    v_and_b32 v73, 0xffff0000, v28
    v_lshlrev_b32 v74, 16, v29
    v_and_b32 v75, 0xffff0000, v29
    v_lshlrev_b32 v76, 16, v30
    v_and_b32 v77, 0xffff0000, v30
    v_lshlrev_b32 v78, 16, v31
    v_and_b32 v79, 0xffff0000, v31
    v_fma_f32 v64, v64, v32, v48
    v_fma_f32 v65, v65, v33, v49
    v_fma_f32 v66, v66, v34, v50
    v_fma_f32 v67, v67, v35, v51
    v_fma_f32 v68, v68, v36, v52
    v_fma_f32 v69, v69, v37, v53
    v_fma_f32 v70, v70, v38, v54
    v_fma_f32 v71, v71, v39, v55
    v_fma_f32 v72, v72, v40, v56
    v_fma_f32 v73, v73, v41, v57
    v_fma_f32 v74, v74, v42, v58
    v_fma_f32 v75, v75, v43, v59
    v_fma_f32 v76, v76, v44, v60
    v_fma_f32 v77, v77, v45, v61
    v_fma_f32 v78, v78, v46, v62
    v_fma_f32 v79, v79, v47, v63
    v_cvt_pk_bf16_f32 v24, v64, v65
    v_cvt_pk_bf16_f32 v25, v66, v67
    v_cvt_pk_bf16_f32 v26, v68, v69
    v_cvt_pk_bf16_f32 v27, v70, v71
    v_cvt_pk_bf16_f32 v28, v72, v73
    v_cvt_pk_bf16_f32 v29, v74, v75
    v_cvt_pk_bf16_f32 v30, v76, v77
    v_cvt_pk_bf16_f32 v31, v78, v79
    v_xor_b32 v2, 64, v96
    ds_write_b128 v96, v[24:27]
    s_waitcnt vmcnt(0)
    s_barrier
    ds_write_b128 v2, v[28:31]
    s_waitcnt lgkmcnt(0)
    ds_read_b128 v[24:27], v97 offset:0
    ds_read_b128 v[28:31], v97 offset:1024
    s_waitcnt lgkmcnt(1)
    buffer_store_dwordx4 v[24:27], v115, s[20:23], s48 offen sc1
    s_waitcnt lgkmcnt(0)
    buffer_store_dwordx4 v[28:31], v115, s[20:23], s49 offen sc1
    v_lshlrev_b32 v64, 16, v16
    v_and_b32 v65, 0xffff0000, v16
    v_lshlrev_b32 v66, 16, v17
    v_and_b32 v67, 0xffff0000, v17
    v_lshlrev_b32 v68, 16, v18
    v_and_b32 v69, 0xffff0000, v18
    v_lshlrev_b32 v70, 16, v19
    v_and_b32 v71, 0xffff0000, v19
    v_lshlrev_b32 v72, 16, v20
    v_and_b32 v73, 0xffff0000, v20
    v_lshlrev_b32 v74, 16, v21
    v_and_b32 v75, 0xffff0000, v21
    v_lshlrev_b32 v76, 16, v22
    v_and_b32 v77, 0xffff0000, v22
    v_lshlrev_b32 v78, 16, v23
    v_and_b32 v79, 0xffff0000, v23
    v_fma_f32 v64, v64, v32, v48
    v_fma_f32 v65, v65, v33, v49
    v_fma_f32 v66, v66, v34, v50
    v_fma_f32 v67, v67, v35, v51
    v_fma_f32 v68, v68, v36, v52
    v_fma_f32 v69, v69, v37, v53
    v_fma_f32 v70, v70, v38, v54
    v_fma_f32 v71, v71, v39, v55
    v_fma_f32 v72, v72, v40, v56
    v_fma_f32 v73, v73, v41, v57
    v_fma_f32 v74, v74, v42, v58
    v_fma_f32 v75, v75, v43, v59
    s_barrier
    v_fma_f32 v76, v76, v44, v60
    v_fma_f32 v77, v77, v45, v61
    v_fma_f32 v78, v78, v46, v62
    v_fma_f32 v79, v79, v47, v63
    v_cvt_pk_bf16_f32 v16, v64, v65
    v_cvt_pk_bf16_f32 v17, v66, v67
    v_cvt_pk_bf16_f32 v18, v68, v69
    v_cvt_pk_bf16_f32 v19, v70, v71
    v_cvt_pk_bf16_f32 v20, v72, v73
    v_cvt_pk_bf16_f32 v21, v74, v75
    v_cvt_pk_bf16_f32 v22, v76, v77
    v_cvt_pk_bf16_f32 v23, v78, v79
    v_xor_b32 v2, 64, v96
    ds_write_b128 v96, v[16:19]
    ds_write_b128 v2, v[20:23]
    s_waitcnt lgkmcnt(0)
    ds_read_b128 v[16:19], v97 offset:0
    ds_read_b128 v[20:23], v97 offset:1024
    s_waitcnt lgkmcnt(1)
    buffer_store_dwordx4 v[16:19], v115, s[20:23], s84 offen sc1
    s_waitcnt lgkmcnt(0)
    buffer_store_dwordx4 v[20:23], v115, s[20:23], s85 offen sc1
    s_barrier
    s_barrier
    s_barrier
    s_barrier
    s_barrier
    s_barrier
    s_barrier
    s_barrier
L_join:
    s_nop 1
    s_add_u32 s95, s98, 917504
    buffer_load_dwordx4 a[0:3], v119, s[16:19], s95 offen
    s_lshl_b32 s80, s72, 7
    s_add_u32 s80, s80, 0
    v_and_b32 v124, 31, v1
    v_lshl_add_u32 v124, v124, 2, s80
    buffer_load_dword v123, v124, s[20:23], 0 offen sc1
    s_mul_i32 s44, s70, 8704
    s_add_u32 s44, s44, 114688
    s_xor_b32 s45, s70, 1
    buffer_load_dwordx4 a[4:7], v120, s[16:19], s95 offen offset:1024
    s_mul_i32 s45, s45, 8704
    s_add_u32 s45, s45, 114688
    v_lshlrev_b32 v2, 4, v1
    v_add_u32 v3, s45, v2
    v_add_u32 v4, s44, v2
    ds_read_b128 v[12:15], v3 offset:0
    ds_read_b128 v[16:19], v3 offset:1024
    s_add_u32 s95, s98, 983040
    buffer_load_dwordx4 a[8:11], v119, s[16:19], s95 offen
    ds_read_b128 v[92:95], v4 offset:2048
    ds_read_b128 v[96:99], v4 offset:3072
    s_lshl_b32 s86, s73, 4
    s_lshr_b32 s87, s42, s86
    s_lshl_b32 s87, s87, 16
    buffer_load_dwordx4 a[12:15], v120, s[16:19], s95 offen offset:1024
    v_and_b32 v20, 31, v1
    v_lshrrev_b32 v21, 5, v1
    s_mul_i32 s88, s73, 4608
    s_add_u32 s88, s88, 149504
    s_cmp_eq_u32 s74, 0
    s_cselect_b32 s87, s87, 0
    v_mov_b32 v24, s87
    v_cmp_eq_u32 vcc, 0, v1
    s_nop 1
    v_cndmask_b32 v24, 0, v24, vcc
    s_waitcnt lgkmcnt(1)
    v_add_f32 v92, v92, v24
    v_add_f32 v92, v92, v12
    s_waitcnt vmcnt(17)
    s_barrier
    s_add_u32 s95, s98, 1048576
    buffer_load_dwordx4 a[16:19], v119, s[16:19], s95 offen
    v_add_f32 v93, v93, v13
    v_add_f32 v94, v94, v14
    v_add_f32 v95, v95, v15
    s_waitcnt lgkmcnt(0)
    v_add_f32 v96, v96, v16
    v_add_f32 v97, v97, v17
    v_add_f32 v98, v98, v18
    v_add_f32 v99, v99, v19
    s_nop 1
    s_cmp_eq_u32 s74, 0
    s_cbranch_scc0 L_kx_5
    v_lshlrev_b32 v22, 4, v20
    v_lshl_add_u32 v23, v21, 3, v22
    v_sub_u32 v23, s88, v23
    v_cvt_pk_bf16_f32 v24, v95, v94
    v_cvt_pk_bf16_f32 v25, v93, v92
    v_cvt_pk_bf16_f32 v26, v98, v97
    v_cvt_pk_bf16_f32 v27, v96, v96
    ds_write_b64 v23, v[24:25] offset:4088
    ds_write_b64 v23, v[26:27] offset:3576
    s_branch L_kx_6
L_kx_5:
    v_lshlrev_b32 v22, 4, v20
    v_lshl_add_u32 v23, v21, 9, v22
    v_sub_u32 v23, s88, v23
    v_cvt_pk_bf16_f32 v24, v94, v94
    v_cvt_pk_bf16_f32 v25, v93, v93
    v_cvt_pk_bf16_f32 v26, v93, v92
    v_cvt_pk_bf16_f32 v27, v92, v92
    ds_write_b128 v23, v[24:27] offset:3056
L_kx_6:
    s_nop 1
    buffer_load_dwordx4 a[20:23], v120, s[16:19], s95 offen offset:1024
    s_add_u32 s95, s98, 1114112
    buffer_load_dwordx4 a[24:27], v119, s[16:19], s95 offen
    s_nop 1
    s_cmp_eq_u32 s74, 0
    s_cbranch_scc0 L_kx_7
    v_mov_b32 v28, 0
    v_mov_b32 v29, 0
    v_mov_b32 v30, 0
    v_mov_b32 v31, 0
    v_add_u32 v22, s88, v22
    ds_write_b128 v22, v[28:31] offset:4096
    s_branch L_kx_8
L_kx_7:
    v_lshl_add_u32 v23, v21, 10, v22
    v_sub_u32 v23, s88, v23
    v_and_b32 v22, 1, v20
    v_cmp_eq_u32 vcc, 1, v22
    s_nop 1
    v_cndmask_b32 v22, v96, v97, vcc
    v_cvt_pk_bf16_f32 v28, v97, v97
    v_cvt_pk_bf16_f32 v29, v97, v22
    v_cvt_pk_bf16_f32 v30, v96, v96
    v_cvt_pk_bf16_f32 v31, v96, v96
    ds_write_b128 v23, v[28:31] offset:2032
L_kx_8:
    s_nop 1
    buffer_load_dwordx4 a[28:31], v120, s[16:19], s95 offen offset:1024
    s_waitcnt vmcnt(15)
    s_barrier
    s_add_u32 s95, s98, 1179648
    buffer_load_dwordx4 a[32:35], v119, s[16:19], s95 offen
    s_nop 1
    s_cmp_eq_u32 s74, 0
    s_cbranch_scc0 L_kx_9
    s_nop 0
    s_branch L_kx_10
L_kx_9:
    v_cndmask_b32 v22, v98, v99, vcc
    v_cvt_pk_bf16_f32 v32, v99, v99
    v_cvt_pk_bf16_f32 v33, v99, v22
    v_cvt_pk_bf16_f32 v34, v98, v98
    v_cvt_pk_bf16_f32 v35, v98, v98
    ds_write_b128 v23, v[32:35] offset:1520
L_kx_10:
    s_nop 1
    buffer_load_dwordx4 a[36:39], v120, s[16:19], s95 offen offset:1024
    s_add_u32 s95, s98, 1245184
    buffer_load_dwordx4 a[40:43], v119, s[16:19], s95 offen
    buffer_load_dwordx4 a[44:47], v120, s[16:19], s95 offen offset:1024
    s_waitcnt lgkmcnt(0)
    s_waitcnt vmcnt(13)
    s_barrier
    s_add_u32 s95, s98, 1310720
    buffer_load_dwordx4 a[48:51], v119, s[16:19], s95 offen
    buffer_load_dwordx4 a[52:55], v120, s[16:19], s95 offen offset:1024
    s_add_u32 s95, s98, 1376256
    buffer_load_dwordx4 a[56:59], v119, s[16:19], s95 offen
    buffer_load_dwordx4 a[60:63], v120, s[16:19], s95 offen offset:1024
    s_waitcnt vmcnt(15)
    v_cmp_eq_u32 vcc, s75, v123
    s_nop 1
    s_cmp_eq_u64 vcc, exec
    s_cbranch_scc1 L_pc_11
    s_mov_b32 s80, 0
L_pl_12:
    buffer_load_dword v123, v124, s[20:23], 0 offen sc1
    s_waitcnt vmcnt(0)
    v_cmp_eq_u32 vcc, s75, v123
    s_add_u32 s80, s80, 1
    s_cmp_gt_u32 s80, 30000
    s_cbranch_scc1 L_pc_11
    s_cmp_eq_u64 vcc, exec
    s_cbranch_scc0 L_pl_12
L_pc_11:
    s_mul_i32 s46, s76, 4096
    s_lshl_b32 s81, s74, 11
    s_add_u32 s46, s46, s81
    s_add_u32 s46, s46, 1048576
    buffer_load_dwordx4 v[40:43], v121, s[20:23], s46 offen offset:0 sc1
    buffer_load_dwordx4 v[44:47], v121, s[20:23], s46 offen offset:1024 sc1
    buffer_load_dwordx4 v[48:51], v121, s[20:23], s46 offen offset:4 sc1
    buffer_load_dwordx4 v[52:55], v121, s[20:23], s46 offen offset:1028 sc1
    buffer_load_dwordx4 v[56:59], v121, s[20:23], s46 offen offset:8 sc1
    buffer_load_dwordx4 v[60:63], v121, s[20:23], s46 offen offset:1032 sc1
    s_barrier
    s_cmp_eq_u32 s74, 1
    s_cselect_b32 s82, 63, 64
    v_cmp_eq_u32 vcc, s82, v1
    s_nop 1
    s_waitcnt vmcnt(2)
    v_cndmask_b32_e64 v55, v55, 0, vcc
    s_waitcnt vmcnt(0)
    v_cndmask_b32_e64 v62, v62, 0, vcc
    v_cndmask_b32_e64 v63, v63, 0, vcc
    v_max3_u32 v64, v40, v41, v42
    v_max3_u32 v64, v64, v43, v44
    v_max3_u32 v64, v64, v45, v46
    v_max3_u32 v64, v64, v47, v48
    v_max3_u32 v64, v64, v49, v50
    v_max3_u32 v64, v64, v51, v52
    v_max3_u32 v64, v64, v53, v54
    v_max3_u32 v64, v64, v55, v56
    v_max3_u32 v64, v64, v57, v58
    v_max3_u32 v64, v64, v59, v60
    v_max3_u32 v64, v64, v61, v62
    v_max_u32 v64, v64, v63
    v_cmp_eq_u32 vcc, -1, v64
    s_nop 1
    s_cmp_eq_u64 vcc, 0
    s_cbranch_scc1 L_uc_13
    s_mov_b32 s80, 0
L_ul_14:
    buffer_load_dwordx4 v[40:43], v121, s[20:23], s46 offen offset:0 sc1
    buffer_load_dwordx4 v[44:47], v121, s[20:23], s46 offen offset:1024 sc1
    buffer_load_dwordx4 v[48:51], v121, s[20:23], s46 offen offset:4 sc1
    buffer_load_dwordx4 v[52:55], v121, s[20:23], s46 offen offset:1028 sc1
    buffer_load_dwordx4 v[56:59], v121, s[20:23], s46 offen offset:8 sc1
    buffer_load_dwordx4 v[60:63], v121, s[20:23], s46 offen offset:1032 sc1
    s_waitcnt vmcnt(0)
    s_cmp_eq_u32 s74, 1
    s_cselect_b32 s82, 63, 64
    v_cmp_eq_u32 vcc, s82, v1
    s_nop 1
    v_cndmask_b32_e64 v55, v55, 0, vcc
    v_cndmask_b32_e64 v62, v62, 0, vcc
    v_cndmask_b32_e64 v63, v63, 0, vcc
    v_max3_u32 v64, v40, v41, v42
    v_max3_u32 v64, v64, v43, v44
    v_max3_u32 v64, v64, v45, v46
    v_max3_u32 v64, v64, v47, v48
    v_max3_u32 v64, v64, v49, v50
    v_max3_u32 v64, v64, v51, v52
    v_max3_u32 v64, v64, v53, v54
    v_max3_u32 v64, v64, v55, v56
    v_max3_u32 v64, v64, v57, v58
    v_max3_u32 v64, v64, v59, v60
    v_max3_u32 v64, v64, v61, v62
    v_max_u32 v64, v64, v63
    v_cmp_eq_u32 vcc, -1, v64
    s_nop 1
    s_add_u32 s80, s80, 1
    s_cmp_gt_u32 s80, 30000
    s_cbranch_scc1 L_uc_13
    s_cmp_eq_u64 vcc, 0
    s_cbranch_scc0 L_ul_14
L_uc_13:
    v_alignbit_b32 v64, v48, v40, 16
    v_alignbit_b32 v72, v56, v48, 16
    v_alignbit_b32 v65, v49, v41, 16
    v_alignbit_b32 v73, v57, v49, 16
    v_alignbit_b32 v66, v50, v42, 16
    v_alignbit_b32 v74, v58, v50, 16
    v_alignbit_b32 v67, v51, v43, 16
    v_alignbit_b32 v75, v59, v51, 16
    v_alignbit_b32 v68, v52, v44, 16
    v_alignbit_b32 v76, v60, v52, 16
    v_alignbit_b32 v69, v53, v45, 16
    v_alignbit_b32 v77, v61, v53, 16
    v_alignbit_b32 v70, v54, v46, 16
    v_alignbit_b32 v78, v62, v54, 16
    v_alignbit_b32 v71, v55, v47, 16
    v_alignbit_b32 v79, v63, v55, 16
    s_mul_i32 s80, s73, 16640
    s_add_u32 s80, s80, 114688
    s_lshl_b32 s81, s74, 11
    s_add_u32 s81, s81, s80
    v_add_u32 v12, s81, v121
    s_nop 1
    s_cmp_eq_u32 s74, 0
    s_cbranch_scc0 L_ch_15
    v_readfirstlane_b32 s82, v40
    v_readfirstlane_b32 s83, v64
    v_mov_b32 v20, 0
    v_mov_b32 v21, 0
    v_mov_b32 v22, 0
    v_mov_b32 v23, 0
    s_lshl_b32 s84, s82, 16
    v_mov_b32 v24, s84
    v_mov_b32 v25, s82
    v_mov_b32 v26, s83
    v_cmp_eq_u32 vcc, 7, v1
    s_nop 1
    v_cndmask_b32 v22, v22, v24, vcc
    v_cndmask_b32 v23, v23, v26, vcc
    v_cmp_eq_u32 vcc, 5, v1
    s_nop 1
    v_cndmask_b32 v23, v23, v25, vcc
    v_cmp_eq_u32 vcc, 3, v1
    s_nop 1
    v_cndmask_b32 v23, v23, v24, vcc
    v_lshrrev_b32 v27, 1, v1
    v_mul_u32_u24 v27, 4160, v27
    v_and_b32 v28, 1, v1
    v_lshl_add_u32 v27, v28, 4, v27
    v_add_u32 v27, s80, v27
    s_mov_b64 exec, 0xff
    ds_write_b128 v27, v[20:23]
    s_mov_b64 exec, -1
    s_branch L_ch_16
L_ch_15:
    s_nop 0
L_ch_16:
    s_nop 1
    ds_write_b128 v12, v[40:43] offset:32
    ds_write_b128 v12, v[44:47] offset:1056
    ds_write_b128 v12, v[64:67] offset:4192
    ds_write_b128 v12, v[68:71] offset:5216
    ds_write_b128 v12, v[48:51] offset:8352
    ds_write_b128 v12, v[52:55] offset:9376
    ds_write_b128 v12, v[72:75] offset:12512
    ds_write_b128 v12, v[76:79] offset:13536
    s_waitcnt lgkmcnt(0)
    s_waitcnt lgkmcnt(0)
    s_barrier
    s_add_u32 m0, s97, 0
    s_add_u32 s95, s98, 0
    buffer_load_dwordx4 v119, s[16:19], s95 offen lds
    buffer_load_dwordx4 v120, s[16:19], s95 offen offset:1024 lds
    s_add_u32 m0, s97, 8192
    s_add_u32 s95, s98, 65536
    buffer_load_dwordx4 v119, s[16:19], s95 offen lds
    buffer_load_dwordx4 v120, s[16:19], s95 offen offset:1024 lds
    s_add_u32 m0, s97, 16384
    s_add_u32 s95, s98, 131072
    buffer_load_dwordx4 v119, s[16:19], s95 offen lds
    buffer_load_dwordx4 v120, s[16:19], s95 offen offset:1024 lds
    s_add_u32 m0, s97, 24576
    s_add_u32 s95, s98, 196608
    buffer_load_dwordx4 v119, s[16:19], s95 offen lds
    buffer_load_dwordx4 v120, s[16:19], s95 offen offset:1024 lds
    s_add_u32 m0, s97, 32768
    s_add_u32 s95, s98, 262144
    buffer_load_dwordx4 v119, s[16:19], s95 offen lds
    buffer_load_dwordx4 v120, s[16:19], s95 offen offset:1024 lds
    s_add_u32 m0, s97, 40960
    s_add_u32 s95, s98, 327680
    buffer_load_dwordx4 v119, s[16:19], s95 offen lds
    buffer_load_dwordx4 v120, s[16:19], s95 offen offset:1024 lds
    s_add_u32 m0, s97, 49152
    s_add_u32 s95, s98, 393216
    buffer_load_dwordx4 v119, s[16:19], s95 offen lds
    buffer_load_dwordx4 v120, s[16:19], s95 offen offset:1024 lds
    s_add_u32 m0, s97, 57344
    s_add_u32 s95, s98, 458752
    buffer_load_dwordx4 v119, s[16:19], s95 offen lds
    buffer_load_dwordx4 v120, s[16:19], s95 offen offset:1024 lds
    s_add_u32 m0, s97, 65536
    s_add_u32 s95, s98, 524288
    buffer_load_dwordx4 v119, s[16:19], s95 offen lds
    buffer_load_dwordx4 v120, s[16:19], s95 offen offset:1024 lds
    s_add_u32 m0, s97, 73728
    s_add_u32 s95, s98, 589824
    buffer_load_dwordx4 v119, s[16:19], s95 offen lds
    buffer_load_dwordx4 v120, s[16:19], s95 offen offset:1024 lds
    s_add_u32 m0, s97, 81920
    s_add_u32 s95, s98, 655360
    buffer_load_dwordx4 v119, s[16:19], s95 offen lds
    buffer_load_dwordx4 v120, s[16:19], s95 offen offset:1024 lds
    s_add_u32 m0, s97, 90112
    s_add_u32 s95, s98, 720896
    buffer_load_dwordx4 v119, s[16:19], s95 offen lds
    buffer_load_dwordx4 v120, s[16:19], s95 offen offset:1024 lds
    s_add_u32 m0, s97, 98304
    s_add_u32 s95, s98, 786432
    buffer_load_dwordx4 v119, s[16:19], s95 offen lds
    buffer_load_dwordx4 v120, s[16:19], s95 offen offset:1024 lds
    s_add_u32 m0, s97, 106496
    s_add_u32 s95, s98, 851968
    buffer_load_dwordx4 v119, s[16:19], s95 offen lds
    buffer_load_dwordx4 v120, s[16:19], s95 offen offset:1024 lds
    v_lshlrev_b32 v64, 16, v80
    v_lshlrev_b32 v2, 16, v100
    v_and_b32 v65, 0xffff0000, v80
    v_and_b32 v3, 0xffff0000, v100
    v_add_f32 v64, v64, v2
    v_add_f32 v65, v65, v3
    v_lshlrev_b32 v66, 16, v81
    v_lshlrev_b32 v2, 16, v101
    v_and_b32 v67, 0xffff0000, v81
    v_and_b32 v3, 0xffff0000, v101
    v_add_f32 v66, v66, v2
    v_add_f32 v67, v67, v3
    v_lshlrev_b32 v68, 16, v82
    v_lshlrev_b32 v2, 16, v102
    v_and_b32 v69, 0xffff0000, v82
    v_and_b32 v3, 0xffff0000, v102
    v_add_f32 v68, v68, v2
    v_add_f32 v69, v69, v3
    v_lshlrev_b32 v70, 16, v83
    v_lshlrev_b32 v2, 16, v103
    v_and_b32 v71, 0xffff0000, v83
    v_and_b32 v3, 0xffff0000, v103
    v_add_f32 v70, v70, v2
    v_add_f32 v71, v71, v3
    v_lshlrev_b32 v72, 16, v84
    v_lshlrev_b32 v2, 16, v104
    v_and_b32 v73, 0xffff0000, v84
    v_and_b32 v3, 0xffff0000, v104
    v_add_f32 v72, v72, v2
    v_add_f32 v73, v73, v3
    v_lshlrev_b32 v74, 16, v85
    v_lshlrev_b32 v2, 16, v105
    v_and_b32 v75, 0xffff0000, v85
    v_and_b32 v3, 0xffff0000, v105
    v_add_f32 v74, v74, v2
    v_add_f32 v75, v75, v3
    v_lshlrev_b32 v76, 16, v86
    v_lshlrev_b32 v2, 16, v106
    v_and_b32 v77, 0xffff0000, v86
    v_and_b32 v3, 0xffff0000, v106
    v_add_f32 v76, v76, v2
    v_add_f32 v77, v77, v3
    v_lshlrev_b32 v78, 16, v87
    v_lshlrev_b32 v2, 16, v107
    v_and_b32 v79, 0xffff0000, v87
    v_and_b32 v3, 0xffff0000, v107
    v_add_f32 v78, v78, v2
    v_add_f32 v79, v79, v3
    s_lshl_b32 s80, s71, 7
    s_add_u32 s80, s80, 4096
    s_cmp_eq_u32 s70, 0
    s_cselect_b32 s80, s80, 0x7ff00000
    v_and_b32 v123, 31, v1
    v_lshl_add_u32 v123, v123, 2, s80
    buffer_load_dword v122, v123, s[20:23], 0 offen sc1
    s_cmp_lg_u32 s70, 0
    s_cbranch_scc1 L_pc_17
    s_waitcnt vmcnt(0)
    v_cmp_eq_u32 vcc, s75, v122
    s_nop 1
    s_and_b32 s81, vcc_lo, 0xffffffff
    s_cmp_eq_u32 s81, 0xffffffff
    s_cbranch_scc1 L_pc_17
    s_mov_b32 s80, 0
L_pl_18:
    buffer_load_dword v122, v123, s[20:23], 0 offen sc1
    s_waitcnt vmcnt(0)
    v_cmp_eq_u32 vcc, s75, v122
    s_add_u32 s80, s80, 1
    s_cmp_gt_u32 s80, 30000
    s_cbranch_scc1 L_pc_17
    s_and_b32 s81, vcc_lo, 0xffffffff
    s_cmp_eq_u32 s81, 0xffffffff
    s_cbranch_scc0 L_pl_18
L_pc_17:
    s_barrier
    s_barrier
    s_and_b32 s80, s70, 2
    s_lshl_b32 s80, s80, 13
    s_lshl_b32 s81, s74, 10
    s_add_u32 s80, s80, s81
    s_add_u32 s80, s80, 114688
    v_add_u32 v2, s80, v121
    ds_read_b128 v[12:15], v2 offset:0
    ds_read_b128 v[28:31], v2 offset:8192
    ds_read_b128 v[16:19], v2 offset:2048
    ds_read_b128 v[32:35], v2 offset:10240
    ds_read_b128 v[20:23], v2 offset:4096
    ds_read_b128 v[36:39], v2 offset:12288
    ds_read_b128 v[24:27], v2 offset:6144
    ds_read_b128 v[40:43], v2 offset:14336
    v_and_b32 v4, 15, v1
    v_lshrrev_b32 v5, 4, v1
    v_lshlrev_b32 v4, 5, v4
    v_lshl_add_u32 v4, v5, 3, v4
    s_mul_i32 s80, s76, 4096
    s_lshl_b32 s81, s74, 9
    s_add_u32 s80, s80, s81
    s_add_u32 s80, s80, 10485760
    s_waitcnt lgkmcnt(6)
    v_add_f32 v12, v12, v28
    v_add_f32 v13, v13, v29
    v_add_f32 v14, v14, v30
    v_add_f32 v15, v15, v31
    v_cvt_pk_bf16_f32 v44, v12, v13
    v_cvt_pk_bf16_f32 v45, v14, v15
    buffer_store_dwordx2 v[44:45], v4, s[20:23], s80 offen offset:0 sc1
    s_waitcnt lgkmcnt(4)
    v_add_f32 v16, v16, v32
    v_add_f32 v17, v17, v33
    v_add_f32 v18, v18, v34
    v_add_f32 v19, v19, v35
    v_cvt_pk_bf16_f32 v46, v16, v17
    v_cvt_pk_bf16_f32 v47, v18, v19
    buffer_store_dwordx2 v[46:47], v4, s[20:23], s80 offen offset:1024 sc1
    s_waitcnt lgkmcnt(2)
    v_add_f32 v20, v20, v36
    v_add_f32 v21, v21, v37
    v_add_f32 v22, v22, v38
    v_add_f32 v23, v23, v39
    v_cvt_pk_bf16_f32 v48, v20, v21
    v_cvt_pk_bf16_f32 v49, v22, v23
    buffer_store_dwordx2 v[48:49], v4, s[20:23], s80 offen offset:2048 sc1
    s_waitcnt lgkmcnt(0)
    v_add_f32 v24, v24, v40
    v_add_f32 v25, v25, v41
    v_add_f32 v26, v26, v42
    v_add_f32 v27, v27, v43
    v_cvt_pk_bf16_f32 v50, v24, v25
    v_cvt_pk_bf16_f32 v51, v26, v27
    buffer_store_dwordx2 v[50:51], v4, s[20:23], s80 offen offset:3072 sc1
    s_barrier
    v_add_u32 v2, s97, v121
    v_add_u32 v3, 114688, v2
    ds_write_b128 v3, a[0:3] offset:0
    ds_write_b128 v3, a[4:7] offset:1024
    ds_write_b128 v3, a[8:11] offset:8192
    ds_write_b128 v3, a[12:15] offset:9216
    ds_write_b128 v3, a[16:19] offset:16384
    ds_write_b128 v3, a[20:23] offset:17408
    ds_write_b128 v3, a[24:27] offset:24576
    ds_write_b128 v3, a[28:31] offset:25600
    ds_write_b128 v3, a[32:35] offset:34816
    ds_write_b128 v3, a[36:39] offset:35840
    ds_write_b128 v2, a[40:43] offset:0
    ds_write_b128 v2, a[44:47] offset:1024
    ds_write_b128 v2, a[48:51] offset:8192
    ds_write_b128 v2, a[52:55] offset:9216
    ds_write_b128 v2, a[56:59] offset:16384
    ds_write_b128 v2, a[60:63] offset:17408
    v_lshrrev_b32 v5, 5, v1
    v_lshrrev_b32 v6, 2, v1
    v_and_b32 v6, 3, v6
    v_lshl_add_u32 v6, v5, 2, v6
    v_lshlrev_b32 v6, 6, v6
    v_lshrrev_b32 v7, 4, v1
    v_and_b32 v7, 1, v7
    v_lshl_add_u32 v6, v7, 5, v6
    v_and_b32 v7, 3, v1
    v_lshl_add_u32 v6, v7, 3, v6
    s_lshl_b32 s80, s70, 11
    s_add_u32 s80, s80, 24576
    v_add_u32 v22, s80, v6
    s_lshl_b32 s80, s70, 12
    s_add_u32 s80, s80, 49152
    v_add_u32 v23, s80, v121
    s_waitcnt lgkmcnt(0)
    s_barrier
    s_setprio 2
    v_lshrrev_b32 v2, 2, v1
    v_and_b32 v3, 3, v1
    v_mul_u32_u24 v2, 4096, v2
    v_lshl_add_u32 v2, v3, 4, v2
    s_mul_i32 s46, s72, 262144
    s_lshl_b32 s81, s71, 7
    s_add_u32 s46, s46, s81
    s_mul_i32 s81, s74, 131072
    s_add_u32 s46, s46, s81
    s_lshl_b32 s81, s73, 6
    s_add_u32 s46, s46, s81
    s_add_u32 s46, s46, 10485760
    s_lshl_b32 s47, s70, 11
    s_add_u32 s47, s47, 24576
    v_add_u32 v3, 64512, v2
    v_add_u32 v4, s47, v121
    s_mov_b32 s80, 0
L_yl_20:
    s_mov_b32 m0, s47
    s_nop 0
    buffer_load_dwordx4 v2, s[20:23], s46 offen sc1 lds
    buffer_load_dwordx4 v3, s[20:23], s46 offen offset:1024 sc1 lds
    s_waitcnt vmcnt(0)
    ds_read_b128 v[12:15], v4
    ds_read_b128 v[16:19], v4 offset:1024
    s_waitcnt lgkmcnt(0)
    v_max3_u32 v20, v12, v13, v14
    v_max3_u32 v20, v20, v15, v16
    v_max3_u32 v20, v20, v17, v18
    v_max_u32 v20, v20, v19
    v_cmp_eq_u32 vcc, -1, v20
    s_nop 1
    s_add_u32 s80, s80, 1
    s_cmp_gt_u32 s80, 30000
    s_cbranch_scc1 L_yc_19
    s_cmp_eq_u64 vcc, 0
    s_cbranch_scc0 L_yl_20
L_yc_19:
    ds_read_b64_tr_b16 v[12:13], v22 offset:0
    ds_read_b64_tr_b16 v[14:15], v22 offset:512
    ds_read_b64_tr_b16 v[16:17], v22 offset:1024
    ds_read_b64_tr_b16 v[18:19], v22 offset:1536
    s_waitcnt lgkmcnt(3)
    v_lshlrev_b32 v2, 16, v12
    v_and_b32 v4, 0xffff0000, v12
    v_add_f32 v64, v64, v2
    v_add_f32 v65, v65, v4
    v_lshlrev_b32 v2, 16, v13
    v_and_b32 v4, 0xffff0000, v13
    v_add_f32 v66, v66, v2
    v_add_f32 v67, v67, v4
    ds_write_b128 v23, v[64:67] offset:0
    s_waitcnt lgkmcnt(3)
    v_lshlrev_b32 v2, 16, v14
    v_and_b32 v4, 0xffff0000, v14
    v_add_f32 v68, v68, v2
    v_add_f32 v69, v69, v4
    v_lshlrev_b32 v2, 16, v15
    v_and_b32 v4, 0xffff0000, v15
    v_add_f32 v70, v70, v2
    v_add_f32 v71, v71, v4
    ds_write_b128 v23, v[68:71] offset:1024
    s_waitcnt lgkmcnt(3)
    v_lshlrev_b32 v2, 16, v16
    v_and_b32 v4, 0xffff0000, v16
    v_add_f32 v72, v72, v2
    v_add_f32 v73, v73, v4
    v_lshlrev_b32 v2, 16, v17
    v_and_b32 v4, 0xffff0000, v17
    v_add_f32 v74, v74, v2
    v_add_f32 v75, v75, v4
    ds_write_b128 v23, v[72:75] offset:2048
    s_waitcnt lgkmcnt(3)
    v_lshlrev_b32 v2, 16, v18
    v_and_b32 v4, 0xffff0000, v18
    v_add_f32 v76, v76, v2
    v_add_f32 v77, v77, v4
    v_lshlrev_b32 v2, 16, v19
    v_and_b32 v4, 0xffff0000, v19
    v_add_f32 v78, v78, v2
    v_add_f32 v79, v79, v4
    ds_write_b128 v23, v[76:79] offset:3072
    s_waitcnt lgkmcnt(0)
    s_barrier
L_exit:
    s_endpgm
L_code_end:
.fill 64, 4, 0xbf800000
.section .rodata,"a"
.p2align 6
.amdhsa_kernel parallel_sum__ssm_conv_s4__dense_activation_squared_relu__prompt_kernel
  .amdhsa_next_free_vgpr 256
  .amdhsa_next_free_sgpr 102
  .amdhsa_accum_offset 128
  .amdhsa_group_segment_fixed_size 0
  .amdhsa_kernarg_size 136
  .amdhsa_user_sgpr_count 2
  .amdhsa_user_sgpr_kernarg_segment_ptr 1
  .amdhsa_system_sgpr_workgroup_id_x 1
.end_amdhsa_kernel
```
